```python
import torch

def _softmax(x, axis=-1):
    return torch.softmax(x, dim=axis)
def _gelu(x):
    return torch.nn.functional.gelu(x, approximate="tanh")
def _silu(x):
    return torch.nn.functional.silu(x)
def _sigmoid(x):
    return torch.sigmoid(x)
def _layernorm(x, axis=-1, eps=1e-5):
    m = x.mean(dim=axis, keepdim=True)
    v = x.var(dim=axis, keepdim=True, unbiased=False)
    return (x - m) / torch.sqrt(v + eps)
def _scatter_add(tgt, idx, src, axis=0):
    return tgt.clone().index_add_(axis, idx, src)
def _segment_sum(src, seg, n):
    out = torch.zeros((n,) + src.shape[1:], dtype=src.dtype)
    return out.index_add_(0, seg, src)
def _pad(x, pw):
    flat = tuple(v for pair in reversed(pw) for v in pair)
    return torch.nn.functional.pad(x, flat)

kernel_name = 'standalone__self_sup_conv_stem_hubert__speech'

def setup_inputs():

    _w = (lambda a: (lambda t: t.to(torch.bfloat16) if t.is_floating_point() else t)(torch.as_tensor(a)))
    B, T, D, K = 2, 4000, 256, 15
    scale = (1.0 / (K * D)) ** 0.5
    return {
        "x": _w((lambda *s: torch.randn(*s, dtype=torch.bfloat16) * 0.05)(B, T, D)),
        "w": _w((lambda *s: torch.randn(*s, dtype=torch.bfloat16) * 0.05)(K, D, D) * scale),
        "b": _w((lambda *s: torch.randn(*s, dtype=torch.bfloat16) * 0.05)(D) * 0.1),
        "gamma": _w(torch.ones((D,), dtype=float)),
        "beta": _w(torch.zeros((D,), dtype=float)),
    }

def reference(x, w, b, gamma, beta):
    B, T, D = x.shape
    K = w.shape[0]
    s = 2
    L = (T - K) // s + 1
    y = torch.einsum('blc,cd->bld', x[:, 0 : s * L : s, :], w[0])
    for i in range(1, K):
        y = y + torch.einsum('blc,cd->bld', x[:, i : i + s * L : s, :], w[i])
    y = y + b[None, None, :]
    mu = y.mean(1, keepdims=True)
    var = ((y - mu) ** 2).mean(1, keepdims=True)
    yn = (y - mu) / torch.sqrt(var + 1e-5)
    yn = yn * gamma[None, None, :] + beta[None, None, :]
    return _gelu(yn)
```

```asm
; @launch grid=(256,1,1) block=(512,1,1) lds=163840
.amdgcn_target "amdgcn-amd-amdhsa--gfx950"
.text
.globl standalone__self_sup_conv_stem_hubert__speech_kernel
.p2align 8
.type standalone__self_sup_conv_stem_hubert__speech_kernel,@function
standalone__self_sup_conv_stem_hubert__speech_kernel:
    s_cmp_ge_u32 s2, 256
    s_cbranch_scc1 L_done
    s_load_dwordx16 s[4:19], s[0:1], 0
    s_getpc_b64 s[96:97]
    v_lshlrev_b32 v30, 6, v0
    v_cmp_gt_u32 vcc, L_done - standalone__self_sup_conv_stem_hubert__speech_kernel - 64, v30
    s_and_saveexec_b64 s[98:99], vcc
    s_cbranch_execz L_nopf
    global_load_dword a127, v30, s[96:97]
L_nopf:
    s_mov_b64 exec, s[98:99]
    v_lshrrev_b32 v32, 6, v0
    v_and_b32 v1, 63, v0
    s_nop 0
    v_readfirstlane_b32 s3, v32
    s_bfe_u32 s37, s2, 0x20001
    s_lshr_b32 s38, s2, 5
    s_lshl_b32 s37, s37, 3
    s_add_u32 s37, s37, s38
    s_bfe_u32 s36, s2, 0x10003
    s_bfe_u32 s38, s2, 0x10004
    s_and_b32 s39, s2, 1
    s_lshl_b32 s39, s39, 1
    s_or_b32 s38, s38, s39
    s_lshr_b32 s39, s37, 4
    s_and_b32 s40, s37, 15
    s_cmp_lt_u32 s3, 4
    s_cbranch_scc1 L_compute
    s_and_b32 s41, s3, 3
    v_bfe_u32 v32, v1, 2, 3
    v_lshrrev_b32 v33, 5, v1
    v_bfe_u32 v34, v1, 4, 1
    v_xor_b32 v34, v34, v1
    v_and_b32 v34, 3, v34
    s_bfe_u32 s57, s40, 0x10001
    v_xor_b32 v34, s57, v34
    v_lshlrev_b32 v32, 12, v32
    v_lshl_add_u32 v32, v33, 6, v32
    v_lshl_add_u32 v17, v34, 4, v32
    v_xor_b32 v18, 32, v17
    v_add_u32 v19, 63488, v17
    v_add_u32 v22, 95232, v18
    v_add_u32 v18, 31744, v18
    s_xor_b32 s42, s40, s38
    s_and_b32 s42, s42, 1
    s_mul_i32 s44, s39, 4000*512
    s_lshl_b32 s45, s40, 17
    s_add_u32 s44, s44, s45
    s_lshl_b32 s45, s41, 10
    s_add_u32 s44, s44, s45
    s_lshl_b32 s45, s36, 8
    s_add_u32 s44, s44, s45
    s_lshl_b32 s45, s42, 7
    s_add_u32 s92, s44, s45
    s_xor_b32 s45, s45, 128
    s_add_u32 s93, s44, s45
    s_lshr_b32 s43, s41, 1
    s_mul_i32 s47, s43, 9216
    s_and_b32 s45, s41, 1
    s_lshl_b32 s46, s45, 9
    s_add_u32 s48, s47, s46
    s_add_u32 s48, s48, 8192
    s_lshl_b32 s46, s45, 12
    s_add_u32 s47, s47, s46
    v_bfe_u32 v32, v1, 2, 2
    v_min_u32 v32, 1, v32
    v_add_u32 v32, 32, v32
    v_lshlrev_b32 v32, 12, v32
    v_bfe_u32 v34, v1, 4, 1
    v_lshl_add_u32 v32, v34, 6, v32
    v_and_b32 v34, 3, v1
    v_xor_b32 v34, s57, v34
    v_lshl_add_u32 v23, v34, 4, v32
    v_lshrrev_b32 v32, 3, v1
    v_bfe_u32 v33, v1, 4, 1
    v_lshlrev_b32 v33, 1, v33
    v_xor_b32 v33, v33, v1
    s_lshl_b32 s46, s45, 2
    v_xor_b32 v33, s46, v33
    v_and_b32 v33, 7, v33
    v_lshlrev_b32 v32, 9, v32
    v_lshl_add_u32 v16, v33, 4, v32
    s_lshl_b32 s57, s57, 12
    v_add_u32 v20, s57, v16
    s_xor_b32 s57, s57, 0x1000
    v_add_u32 v21, s57, v16
    s_lshl_b32 s44, s45, 14
    s_lshl_b32 s45, s43, 13
    s_add_u32 s44, s44, s45
    s_lshl_b32 s45, s38, 7
    s_add_u32 s44, s44, s45
    s_lshl_b32 s45, s36, 16
    s_add_u32 s44, s44, s45
    s_lshl_b32 s45, s42, 15
    s_add_u32 s88, s44, s45
    s_xor_b32 s45, s45, 0x8000
    s_add_u32 s89, s44, s45
    s_lshl_b32 s46, s41, 10
    s_add_u32 s46, s46, 73728
    s_bfe_u32 s58, s40, 0x10002
    s_bfe_u32 s59, s40, 0x10000
    s_lshl_b32 s59, s59, 1
    s_or_b32 s58, s58, s59
    s_xor_b32 s59, s58, 0
    s_lshl_b32 s76, s59, 12
    s_lshl_b32 s80, s59, 18
    s_xor_b32 s59, s58, 1
    s_lshl_b32 s77, s59, 12
    s_lshl_b32 s81, s59, 18
    s_xor_b32 s59, s58, 2
    s_lshl_b32 s78, s59, 12
    s_lshl_b32 s82, s59, 18
    s_xor_b32 s59, s58, 3
    s_lshl_b32 s79, s59, 12
    s_lshl_b32 s83, s59, 18
    s_mov_b32 s22, 4096000
    s_mov_b32 s23, 0x20000
    s_mov_b32 s26, 1966080
    s_mov_b32 s27, 0x20000
    s_waitcnt lgkmcnt(0)
    s_mov_b32 s20, s4
    s_and_b32 s21, s5, 0xffff
    s_mov_b32 s24, s6
    s_and_b32 s25, s7, 0xffff
    s_add_u32 m0, s47, 0
    s_add_u32 s56, s92, 0
    buffer_load_dwordx4 v17, s[20:23], s56 offen offset:0  lds
    buffer_load_dwordx4 v18, s[20:23], s56 offen offset:1024  lds
    buffer_load_dwordx4 v19, s[20:23], s56 offen offset:2048  lds
    buffer_load_dwordx4 v22, s[20:23], s56 offen offset:3072  lds
    s_add_u32 m0, s48, 0
    s_add_u32 s56, s92, 0
    s_mov_b32 exec_hi, 0
    buffer_load_dwordx4 v23, s[20:23], s56 offen  lds
    s_mov_b32 exec_hi, -1
    s_add_u32 m0, s46, 0
    s_add_u32 s56, s88, 0
    buffer_load_dwordx4 v20, s[24:27], s56 offen  lds
    s_add_u32 m0, s46, 4096
    s_add_u32 s56, s88, 262144
    buffer_load_dwordx4 v20, s[24:27], s56 offen  lds
    s_add_u32 m0, s46, 8192
    s_add_u32 s56, s88, 524288
    buffer_load_dwordx4 v20, s[24:27], s56 offen  lds
    s_add_u32 m0, s46, 12288
    s_add_u32 s56, s88, 786432
    buffer_load_dwordx4 v20, s[24:27], s56 offen  lds
    s_add_u32 s58, s46, 16384
    s_add_u32 s59, s88, 1048576
    s_add_u32 m0, s58, s76
    s_add_u32 s56, s59, s80
    buffer_load_dwordx4 v20, s[24:27], s56 offen  lds
    s_add_u32 m0, s58, s77
    s_add_u32 s56, s59, s81
    buffer_load_dwordx4 v20, s[24:27], s56 offen  lds
    s_add_u32 m0, s58, s78
    s_add_u32 s56, s59, s82
    buffer_load_dwordx4 v20, s[24:27], s56 offen  lds
    s_add_u32 m0, s58, s79
    s_add_u32 s56, s59, s83
    s_waitcnt vmcnt(11)
    buffer_load_dwordx4 v20, s[24:27], s56 offen  lds
    s_add_u32 s58, s46, 32768
    s_add_u32 s59, s88, 0
    s_add_u32 m0, s58, s76
    s_add_u32 s56, s59, s80
    s_waitcnt vmcnt(11)
    buffer_load_dwordx4 v21, s[24:27], s56 offen  lds
    s_add_u32 m0, s58, s77
    s_add_u32 s56, s59, s81
    s_waitcnt vmcnt(11)
    buffer_load_dwordx4 v21, s[24:27], s56 offen  lds
    s_add_u32 m0, s58, s78
    s_add_u32 s56, s59, s82
    s_waitcnt vmcnt(11)
    buffer_load_dwordx4 v21, s[24:27], s56 offen  lds
    s_add_u32 m0, s58, s79
    s_add_u32 s56, s59, s83
    s_waitcnt vmcnt(11)
    buffer_load_dwordx4 v21, s[24:27], s56 offen  lds
    s_branch L_ld2
L_compute:
    s_setprio 1
    s_lshr_b32 s41, s3, 1
    s_and_b32 s42, s3, 1
    s_lshl_b32 s43, s41, 4
    v_and_b32 v32, 15, v1
    v_add_u32 v32, s43, v32
    v_lshrrev_b32 v33, 4, v1
    v_and_b32 v34, 1, v33
    v_and_b32 v35, 2, v33
    v_add_u32 v36, 0, v32
    v_bfe_u32 v37, v36, 2, 2
    v_xor_b32 v37, v37, v35
    v_lshrrev_b32 v38, 3, v36
    v_lshlrev_b32 v38, 4, v38
    v_lshl_add_u32 v38, v34, 3, v38
    v_and_b32 v39, 7, v36
    v_add_u32 v38, v38, v39
    v_lshlrev_b32 v38, 6, v38
    v_lshl_add_u32 v16, v37, 4, v38
    v_add_u32 v36, 1, v32
    v_bfe_u32 v37, v36, 2, 2
    v_xor_b32 v37, v37, v35
    v_lshrrev_b32 v38, 3, v36
    v_lshlrev_b32 v38, 4, v38
    v_lshl_add_u32 v38, v34, 3, v38
    v_and_b32 v39, 7, v36
    v_add_u32 v38, v38, v39
    v_lshl_add_u32 v39, v34, 2, v39
    v_add_u32 v39, 128, v39
    v_cmp_lt_u32 vcc, 31, v36
    v_add_u32 v40, 64, v38
    v_add_u32 v41, 8, v39
    v_cndmask_b32 v38, v38, v39, vcc
    v_cndmask_b32 v40, v40, v41, vcc
    v_lshlrev_b32 v38, 6, v38
    v_lshlrev_b32 v40, 6, v40
    v_lshl_add_u32 v18, v37, 4, v38
    v_lshl_add_u32 v20, v37, 4, v40
    v_add_u32 v36, 2, v32
    v_bfe_u32 v37, v36, 2, 2
    v_xor_b32 v37, v37, v35
    v_lshrrev_b32 v38, 3, v36
    v_lshlrev_b32 v38, 4, v38
    v_lshl_add_u32 v38, v34, 3, v38
    v_and_b32 v39, 7, v36
    v_add_u32 v38, v38, v39
    v_lshl_add_u32 v39, v34, 2, v39
    v_add_u32 v39, 128, v39
    v_cmp_lt_u32 vcc, 31, v36
    v_add_u32 v40, 64, v38
    v_add_u32 v41, 8, v39
    v_cndmask_b32 v38, v38, v39, vcc
    v_cndmask_b32 v40, v40, v41, vcc
    v_lshlrev_b32 v38, 6, v38
    v_lshlrev_b32 v40, 6, v40
    v_lshl_add_u32 v22, v37, 4, v38
    v_lshl_add_u32 v24, v37, 4, v40
    v_xor_b32 v17, 16, v16
    v_xor_b32 v19, 16, v18
    v_xor_b32 v21, 16, v20
    v_xor_b32 v23, 16, v22
    v_xor_b32 v25, 16, v24
    s_lshl_b32 s43, s36, 1
    s_or_b32 s43, s43, s42
    v_bfe_u32 v36, v1, 2, 2
    v_lshl_add_u32 v36, v33, 3, v36
    v_lshlrev_b32 v36, 7, v36
    v_bfe_u32 v37, v1, 3, 1
    v_lshl_add_u32 v37, v34, 1, v37
    v_xor_b32 v37, s43, v37
    v_lshl_add_u32 v36, v37, 5, v36
    v_and_b32 v37, 3, v1
    v_lshl_add_u32 v36, v37, 3, v36
    v_add_u32 v26, 73728, v36
    v_add_u32 v27, 118784, v36
    v_xor_b32 v28, 64, v26
    v_xor_b32 v29, 64, v27
    s_waitcnt lgkmcnt(0)
    s_mul_i32 s53, s39, 1993*512
    s_lshl_b32 s52, s40, 16
    s_add_u32 s53, s53, s52
    v_mov_b32 v41, s53
    v_mov_b32 v40, 0
    s_mul_i32 s52, s2, 16640
    s_add_u32 s52, s52, 1064960
    v_mov_b32 v39, s52
    global_load_dword a127, v39, s[18:19]
    global_load_dword a127, v41, s[14:15]
    s_mov_b32 s32, s18
    s_and_b32 s33, s19, 0xffff
    s_mov_b32 s34, 16777216
    s_mov_b32 s35, 0x20000
    s_lshl_b32 s50, s39, 2
    s_add_u32 s50, s50, s38
    s_lshl_b32 s51, s50, 8
    buffer_load_dword v2, off, s[32:35], s51 sc1
    s_lshl_b32 s52, s38, 7
    s_lshl_b32 s53, s36, 6
    s_add_u32 s52, s52, s53
    s_lshl_b32 s53, s3, 3
    s_add_u32 s53, s52, s53
    v_and_b32 v32, 3, v1
    v_lshl_add_u32 v33, v32, 1, s53
    global_load_ushort v3, v33, s[8:9]
    global_load_ushort v4, v33, s[10:11]
    global_load_ushort v5, v33, s[12:13]
    s_barrier
    ds_read_b64_tr_b16 v[76:77], v26 offset:0
    ds_read_b64_tr_b16 v[78:79], v26 offset:512
    ds_read_b128 v[80:83], v16 offset:0
    ds_read_b64_tr_b16 v[84:85], v26 offset:4096
    ds_read_b64_tr_b16 v[86:87], v26 offset:4608
    ds_read_b128 v[88:91], v16 offset:4096
    ds_read_b128 v[92:95], v16 offset:9216
    ds_read_b128 v[96:99], v16 offset:13312
    ds_read_b128 v[100:103], v18 offset:0
    ds_read_b64_tr_b16 v[104:105], v28 offset:0
    s_waitcnt lgkmcnt(7)
    v_mfma_f32_16x16x32_bf16 v[44:47], v[76:79], v[80:83], 0
    ds_read_b64_tr_b16 v[106:107], v28 offset:512
    s_waitcnt lgkmcnt(5)
    v_mfma_f32_16x16x32_bf16 v[44:47], v[84:87], v[88:91], v[44:47]
    ds_read_b64_tr_b16 v[108:109], v28 offset:4096
    v_mfma_f32_16x16x32_bf16 v[48:51], v[76:79], v[88:91], 0
    ds_read_b64_tr_b16 v[110:111], v28 offset:4608
    s_waitcnt lgkmcnt(6)
    v_mfma_f32_16x16x32_bf16 v[48:51], v[84:87], v[92:95], v[48:51]
    s_waitcnt lgkmcnt(4)
    v_mfma_f32_16x16x32_bf16 v[52:55], v[76:79], v[92:95], 0
    s_mul_i32 s53, s39, 1993*512
    v_mfma_f32_16x16x32_bf16 v[52:55], v[84:87], v[96:99], v[52:55]
    s_add_u32 s28, s14, s53
    s_addc_u32 s29, s15, 0
    v_mfma_f32_16x16x32_bf16 v[56:59], v[76:79], v[96:99], 0
    s_and_b32 s29, s29, 0xffff
    v_mfma_f32_16x16x32_bf16 v[56:59], v[84:87], v[100:103], v[56:59]
    s_barrier
    ds_read_b64_tr_b16 v[112:113], v26 offset:8192
    s_mov_b32 s30, 1993*512
    s_waitcnt lgkmcnt(1)
    v_mfma_f32_16x16x32_bf16 v[60:63], v[104:107], v[80:83], 0
    ds_read_b64_tr_b16 v[114:115], v26 offset:8704
    s_mov_b32 s31, 0x20000
    v_mfma_f32_16x16x32_bf16 v[60:63], v[108:111], v[88:91], v[60:63]
    ds_read_b64_tr_b16 v[116:117], v26 offset:12288
    s_lshl_b32 s54, s50, 1
    v_mfma_f32_16x16x32_bf16 v[64:67], v[104:107], v[88:91], 0
    ds_read_b64_tr_b16 v[118:119], v26 offset:12800
    s_add_u32 s54, s54, s36
    v_mfma_f32_16x16x32_bf16 v[64:67], v[108:111], v[92:95], v[64:67]
    s_lshl_b32 s54, s54, 14
    v_mfma_f32_16x16x32_bf16 v[68:71], v[104:107], v[92:95], 0
    s_add_u32 s54, s54, 65536
    v_mfma_f32_16x16x32_bf16 v[68:71], v[108:111], v[96:99], v[68:71]
    ds_read_b128 v[120:123], v20 offset:0
    s_lshl_b32 s55, s40, 10
    v_mfma_f32_16x16x32_bf16 v[72:75], v[104:107], v[96:99], 0
    ds_read_b128 v[124:127], v18 offset:9216
    s_add_u32 s55, s55, s54
    v_mfma_f32_16x16x32_bf16 v[72:75], v[108:111], v[100:103], v[72:75]
    ds_read_b64_tr_b16 v[76:77], v28 offset:8192
    v_lshrrev_b32 v33, 2, v1
    s_waitcnt lgkmcnt(3)
    v_mfma_f32_16x16x32_bf16 v[44:47], v[112:115], v[92:95], v[44:47]
    ds_read_b64_tr_b16 v[78:79], v28 offset:8704
    v_lshlrev_b32 v34, 9, v33
    v_mfma_f32_16x16x32_bf16 v[44:47], v[116:119], v[96:99], v[44:47]
    ds_read_b64_tr_b16 v[84:85], v28 offset:12288
    v_lshl_add_u32 v34, v32, 4, v34
    v_mfma_f32_16x16x32_bf16 v[48:51], v[112:115], v[96:99], v[48:51]
    ds_read_b64_tr_b16 v[86:87], v28 offset:12800
    s_lshl_b32 s53, s3, 6
    v_mfma_f32_16x16x32_bf16 v[48:51], v[116:119], v[100:103], v[48:51]
    v_add_u32 v9, s53, v34
    s_waitcnt lgkmcnt(4)
    v_mfma_f32_16x16x32_bf16 v[52:55], v[112:115], v[100:103], v[52:55]
    s_lshl_b32 s53, s3, 4
    v_mfma_f32_16x16x32_bf16 v[52:55], v[116:119], v[120:123], v[52:55]
    s_add_u32 s53, s53, 16384
    v_mfma_f32_16x16x32_bf16 v[56:59], v[112:115], v[120:123], v[56:59]
    v_lshl_add_u32 v10, v32, 2, s53
    v_mfma_f32_16x16x32_bf16 v[56:59], v[116:119], v[124:127], v[56:59]
    s_barrier
    ds_read_b64_tr_b16 v[80:81], v26 offset:16384
    v_lshlrev_b32 v34, 5, v32
    s_waitcnt lgkmcnt(1)
    v_mfma_f32_16x16x32_bf16 v[60:63], v[76:79], v[92:95], v[60:63]
    ds_read_b64_tr_b16 v[82:83], v26 offset:16896
    v_add_u32 v11, 16384, v34
    v_mfma_f32_16x16x32_bf16 v[60:63], v[84:87], v[96:99], v[60:63]
    ds_read_b64_tr_b16 v[88:89], v26 offset:20480
    s_lshl_b32 s53, s3, 4
    v_mfma_f32_16x16x32_bf16 v[64:67], v[76:79], v[96:99], v[64:67]
    ds_read_b64_tr_b16 v[90:91], v26 offset:20992
    v_add_u32 v33, s53, v33
    v_mfma_f32_16x16x32_bf16 v[64:67], v[84:87], v[100:103], v[64:67]
    s_lshl_b32 s53, s40, 7
    v_mfma_f32_16x16x32_bf16 v[68:71], v[76:79], v[100:103], v[68:71]
    v_add_u32 v34, s53, v33
    v_mfma_f32_16x16x32_bf16 v[68:71], v[84:87], v[120:123], v[68:71]
    ds_read_b128 v[104:107], v20 offset:9216
    v_lshlrev_b32 v34, 9, v34
    v_mfma_f32_16x16x32_bf16 v[72:75], v[76:79], v[120:123], v[72:75]
    ds_read_b128 v[108:111], v22 offset:0
    v_lshl_add_u32 v34, v32, 4, v34
    v_mfma_f32_16x16x32_bf16 v[72:75], v[84:87], v[124:127], v[72:75]
    ds_read_b64_tr_b16 v[112:113], v28 offset:16384
    v_add_u32 v6, s52, v34
    s_waitcnt lgkmcnt(3)
    v_mfma_f32_16x16x32_bf16 v[44:47], v[80:83], v[100:103], v[44:47]
    ds_read_b64_tr_b16 v[114:115], v28 offset:16896
    v_bfe_u32 v34, v33, 2, 3
    v_mfma_f32_16x16x32_bf16 v[44:47], v[88:91], v[120:123], v[44:47]
    ds_read_b64_tr_b16 v[116:117], v28 offset:20480
    v_lshlrev_b32 v35, 1, v32
    v_mfma_f32_16x16x32_bf16 v[48:51], v[80:83], v[120:123], v[48:51]
    ds_read_b64_tr_b16 v[118:119], v28 offset:20992
    v_xor_b32 v34, v34, v35
    v_mfma_f32_16x16x32_bf16 v[48:51], v[88:91], v[124:127], v[48:51]
    v_lshlrev_b32 v35, 7, v33
    s_waitcnt lgkmcnt(4)
    v_mfma_f32_16x16x32_bf16 v[52:55], v[80:83], v[124:127], v[52:55]
    v_lshl_add_u32 v34, v34, 4, v35
    v_mfma_f32_16x16x32_bf16 v[52:55], v[88:91], v[104:107], v[52:55]
    v_add_u32 v13, 0, v34
    v_mfma_f32_16x16x32_bf16 v[56:59], v[80:83], v[104:107], v[56:59]
    v_xor_b32 v14, 16, v13
    v_mfma_f32_16x16x32_bf16 v[56:59], v[88:91], v[108:111], v[56:59]
    ds_read_b64_tr_b16 v[92:93], v26 offset:24576
    v_and_b32 v32, 15, v1
    s_waitcnt lgkmcnt(1)
    v_mfma_f32_16x16x32_bf16 v[60:63], v[112:115], v[100:103], v[60:63]
    ds_read_b64_tr_b16 v[94:95], v26 offset:25088
    v_lshrrev_b32 v33, 4, v1
    v_mfma_f32_16x16x32_bf16 v[60:63], v[116:119], v[120:123], v[60:63]
    ds_read_b64_tr_b16 v[96:97], v26 offset:28672
    s_lshl_b32 s53, s40, 7
    v_mfma_f32_16x16x32_bf16 v[64:67], v[112:115], v[120:123], v[64:67]
    ds_read_b64_tr_b16 v[98:99], v26 offset:29184
    s_lshl_b32 s56, s41, 6
    v_mfma_f32_16x16x32_bf16 v[64:67], v[116:119], v[124:127], v[64:67]
    s_add_u32 s53, s53, s56
    v_mfma_f32_16x16x32_bf16 v[68:71], v[112:115], v[124:127], v[68:71]
    v_lshl_add_u32 v34, v32, 2, s53
    v_mfma_f32_16x16x32_bf16 v[68:71], v[116:119], v[104:107], v[68:71]
    ds_read_b128 v[76:79], v24 offset:0
    v_sub_u32 v7, 1993, v34
    v_mfma_f32_16x16x32_bf16 v[72:75], v[112:115], v[104:107], v[72:75]
    ds_read_b128 v[84:87], v22 offset:9216
    v_lshlrev_b32 v34, 6, v33
    v_mfma_f32_16x16x32_bf16 v[72:75], v[116:119], v[108:111], v[72:75]
    ds_read_b64_tr_b16 v[80:81], v28 offset:24576
    v_bfe_u32 v35, v1, 2, 1
    s_waitcnt lgkmcnt(3)
    v_mfma_f32_16x16x32_bf16 v[44:47], v[92:95], v[124:127], v[44:47]
    ds_read_b64_tr_b16 v[82:83], v28 offset:25088
    v_lshl_add_u32 v34, v35, 5, v34
    v_mfma_f32_16x16x32_bf16 v[44:47], v[96:99], v[104:107], v[44:47]
    ds_read_b64_tr_b16 v[88:89], v28 offset:28672
    v_and_b32 v35, 1, v1
    v_mfma_f32_16x16x32_bf16 v[48:51], v[92:95], v[104:107], v[48:51]
    ds_read_b64_tr_b16 v[90:91], v28 offset:29184
    v_lshl_add_u32 v34, v35, 4, v34
    v_mfma_f32_16x16x32_bf16 v[48:51], v[96:99], v[108:111], v[48:51]
    v_bfe_u32 v35, v1, 3, 1
    s_waitcnt lgkmcnt(4)
    v_mfma_f32_16x16x32_bf16 v[52:55], v[92:95], v[108:111], v[52:55]
    s_barrier
    ds_read_b64_tr_b16 v[100:101], v26 offset:32768
    v_lshl_add_u32 v34, v35, 3, v34
    v_mfma_f32_16x16x32_bf16 v[52:55], v[96:99], v[76:79], v[52:55]
    ds_read_b64_tr_b16 v[102:103], v26 offset:33280
    s_lshl_b32 s53, s3, 8
    v_mfma_f32_16x16x32_bf16 v[56:59], v[92:95], v[76:79], v[56:59]
    ds_read_b128 v[120:123], v17 offset:0
    v_add_u32 v8, s53, v34
    v_mfma_f32_16x16x32_bf16 v[56:59], v[96:99], v[84:87], v[56:59]
    ds_read_b64_tr_b16 v[112:113], v26 offset:36864
    s_lshl_b32 s53, s42, 2
    s_waitcnt lgkmcnt(4)
    v_mfma_f32_16x16x32_bf16 v[60:63], v[80:83], v[124:127], v[60:63]
    ds_read_b64_tr_b16 v[114:115], v26 offset:37376
    v_add_u32 v34, s53, v33
    v_mfma_f32_16x16x32_bf16 v[60:63], v[88:91], v[104:107], v[60:63]
    ds_read_b128 v[116:119], v17 offset:4096
    v_and_b32 v35, 7, v32
    v_mfma_f32_16x16x32_bf16 v[64:67], v[80:83], v[104:107], v[64:67]
    ds_read_b128 v[92:95], v17 offset:9216
    v_xor_b32 v34, v34, v35
    v_mfma_f32_16x16x32_bf16 v[64:67], v[88:91], v[108:111], v[64:67]
    v_lshlrev_b32 v35, 9, v32
    v_mfma_f32_16x16x32_bf16 v[68:71], v[80:83], v[108:111], v[68:71]
    v_lshl_add_u32 v34, v34, 4, v35
    v_mfma_f32_16x16x32_bf16 v[68:71], v[88:91], v[76:79], v[68:71]
    ds_read_b128 v[96:99], v17 offset:13312
    s_lshl_b32 s53, s41, 13
    v_mfma_f32_16x16x32_bf16 v[72:75], v[80:83], v[76:79], v[72:75]
    ds_read_b128 v[124:127], v19 offset:0
    s_add_u32 s53, s53, 0
    v_mfma_f32_16x16x32_bf16 v[72:75], v[88:91], v[84:87], v[72:75]
    ds_read_b64_tr_b16 v[104:105], v28 offset:32768
    v_add_u32 v12, s53, v34
    s_waitcnt lgkmcnt(3)
    v_mfma_f32_16x16x32_bf16 v[44:47], v[100:103], v[120:123], v[44:47]
    ds_read_b64_tr_b16 v[106:107], v28 offset:33280
    s_lshl_b32 s53, s3, 12
    v_mfma_f32_16x16x32_bf16 v[44:47], v[112:115], v[116:119], v[44:47]
    ds_read_b64_tr_b16 v[108:109], v28 offset:36864
    v_lshl_add_u32 v15, v1, 4, s53
    v_mfma_f32_16x16x32_bf16 v[48:51], v[100:103], v[116:119], v[48:51]
    ds_read_b64_tr_b16 v[110:111], v28 offset:37376
    s_mul_i32 s44, s2, 16640
    v_mfma_f32_16x16x32_bf16 v[48:51], v[112:115], v[92:95], v[48:51]
    s_add_u32 s44, s44, 1048576
    s_waitcnt lgkmcnt(4)
    v_mfma_f32_16x16x32_bf16 v[52:55], v[100:103], v[92:95], v[52:55]
    s_xor_b32 s45, s2, 8
    v_mfma_f32_16x16x32_bf16 v[52:55], v[112:115], v[96:99], v[52:55]
    s_mul_i32 s45, s45, 16640
    v_mfma_f32_16x16x32_bf16 v[56:59], v[100:103], v[96:99], v[56:59]
    s_add_u32 s45, s45, 1048576
    v_mfma_f32_16x16x32_bf16 v[56:59], v[112:115], v[124:127], v[56:59]
    ds_read_b64_tr_b16 v[76:77], v26 offset:40960
    s_waitcnt lgkmcnt(1)
    v_mfma_f32_16x16x32_bf16 v[60:63], v[104:107], v[120:123], v[60:63]
    ds_read_b64_tr_b16 v[78:79], v26 offset:41472
    v_mfma_f32_16x16x32_bf16 v[60:63], v[108:111], v[116:119], v[60:63]
    ds_read_b64_tr_b16 v[80:81], v27 offset:0
    v_mfma_f32_16x16x32_bf16 v[64:67], v[104:107], v[116:119], v[64:67]
    ds_read_b64_tr_b16 v[82:83], v27 offset:512
    v_mfma_f32_16x16x32_bf16 v[64:67], v[108:111], v[92:95], v[64:67]
    v_mfma_f32_16x16x32_bf16 v[68:71], v[104:107], v[92:95], v[68:71]
    v_mfma_f32_16x16x32_bf16 v[68:71], v[108:111], v[96:99], v[68:71]
    ds_read_b128 v[84:87], v21 offset:0
    v_mfma_f32_16x16x32_bf16 v[72:75], v[104:107], v[96:99], v[72:75]
    ds_read_b128 v[88:91], v19 offset:9216
    v_mfma_f32_16x16x32_bf16 v[72:75], v[108:111], v[124:127], v[72:75]
    ds_read_b64_tr_b16 v[100:101], v28 offset:40960
    s_waitcnt lgkmcnt(3)
    v_mfma_f32_16x16x32_bf16 v[44:47], v[76:79], v[92:95], v[44:47]
    ds_read_b64_tr_b16 v[102:103], v28 offset:41472
    v_mfma_f32_16x16x32_bf16 v[44:47], v[80:83], v[96:99], v[44:47]
    ds_read_b64_tr_b16 v[112:113], v29 offset:0
    v_mfma_f32_16x16x32_bf16 v[48:51], v[76:79], v[96:99], v[48:51]
    ds_read_b64_tr_b16 v[114:115], v29 offset:512
    v_mfma_f32_16x16x32_bf16 v[48:51], v[80:83], v[124:127], v[48:51]
    s_waitcnt lgkmcnt(4)
    v_mfma_f32_16x16x32_bf16 v[52:55], v[76:79], v[124:127], v[52:55]
    v_mfma_f32_16x16x32_bf16 v[52:55], v[80:83], v[84:87], v[52:55]
    v_mfma_f32_16x16x32_bf16 v[56:59], v[76:79], v[84:87], v[56:59]
    v_mfma_f32_16x16x32_bf16 v[56:59], v[80:83], v[88:91], v[56:59]
    s_barrier
    ds_read_b64_tr_b16 v[120:121], v27 offset:4096
    s_waitcnt lgkmcnt(1)
    v_mfma_f32_16x16x32_bf16 v[60:63], v[100:103], v[92:95], v[60:63]
    ds_read_b64_tr_b16 v[122:123], v27 offset:4608
    v_mfma_f32_16x16x32_bf16 v[60:63], v[112:115], v[96:99], v[60:63]
    ds_read_b64_tr_b16 v[116:117], v27 offset:8192
    v_mfma_f32_16x16x32_bf16 v[64:67], v[100:103], v[96:99], v[64:67]
    ds_read_b64_tr_b16 v[118:119], v27 offset:8704
    v_mfma_f32_16x16x32_bf16 v[64:67], v[112:115], v[124:127], v[64:67]
    v_mfma_f32_16x16x32_bf16 v[68:71], v[100:103], v[124:127], v[68:71]
    v_mfma_f32_16x16x32_bf16 v[68:71], v[112:115], v[84:87], v[68:71]
    ds_read_b128 v[104:107], v21 offset:9216
    s_waitcnt vmcnt(0)
    v_add_u32 v2, 0x9e3779b8, v2
    v_or_b32 v2, 1, v2
    v_mfma_f32_16x16x32_bf16 v[72:75], v[100:103], v[84:87], v[72:75]
    ds_read_b128 v[108:111], v23 offset:0
    v_mfma_f32_16x16x32_bf16 v[72:75], v[112:115], v[88:91], v[72:75]
    ds_read_b64_tr_b16 v[76:77], v29 offset:4096
    v_lshlrev_b32 v3, 16, v3
    s_waitcnt lgkmcnt(3)
    v_mfma_f32_16x16x32_bf16 v[44:47], v[120:123], v[124:127], v[44:47]
    ds_read_b64_tr_b16 v[78:79], v29 offset:4608
    v_mfma_f32_16x16x32_bf16 v[44:47], v[116:119], v[84:87], v[44:47]
    ds_read_b64_tr_b16 v[80:81], v29 offset:8192
    v_lshlrev_b32 v4, 16, v4
    v_mfma_f32_16x16x32_bf16 v[48:51], v[120:123], v[84:87], v[48:51]
    ds_read_b64_tr_b16 v[82:83], v29 offset:8704
    v_mfma_f32_16x16x32_bf16 v[48:51], v[116:119], v[88:91], v[48:51]
    v_lshlrev_b32 v5, 16, v5
    s_waitcnt lgkmcnt(4)
    v_mfma_f32_16x16x32_bf16 v[52:55], v[120:123], v[88:91], v[52:55]
    v_mfma_f32_16x16x32_bf16 v[52:55], v[116:119], v[104:107], v[52:55]
    v_mfma_f32_16x16x32_bf16 v[56:59], v[120:123], v[104:107], v[56:59]
    v_mfma_f32_16x16x32_bf16 v[56:59], v[116:119], v[108:111], v[56:59]
    ds_read_b64_tr_b16 v[92:93], v27 offset:12288
    s_waitcnt lgkmcnt(1)
    v_mfma_f32_16x16x32_bf16 v[60:63], v[76:79], v[124:127], v[60:63]
    ds_read_b64_tr_b16 v[94:95], v27 offset:12800
    v_mfma_f32_16x16x32_bf16 v[60:63], v[80:83], v[84:87], v[60:63]
    ds_read_b64_tr_b16 v[96:97], v27 offset:16384
    v_mfma_f32_16x16x32_bf16 v[64:67], v[76:79], v[84:87], v[64:67]
    ds_read_b64_tr_b16 v[98:99], v27 offset:16896
    v_mfma_f32_16x16x32_bf16 v[64:67], v[80:83], v[88:91], v[64:67]
    v_mfma_f32_16x16x32_bf16 v[68:71], v[76:79], v[88:91], v[68:71]
    v_mfma_f32_16x16x32_bf16 v[68:71], v[80:83], v[104:107], v[68:71]
    ds_read_b128 v[100:103], v25 offset:0
    v_mfma_f32_16x16x32_bf16 v[72:75], v[76:79], v[104:107], v[72:75]
    ds_read_b128 v[112:115], v23 offset:9216
    v_mfma_f32_16x16x32_bf16 v[72:75], v[80:83], v[108:111], v[72:75]
    ds_read_b64_tr_b16 v[120:121], v29 offset:12288
    s_waitcnt lgkmcnt(3)
    v_mfma_f32_16x16x32_bf16 v[44:47], v[92:95], v[88:91], v[44:47]
    ds_read_b64_tr_b16 v[122:123], v29 offset:12800
    v_mfma_f32_16x16x32_bf16 v[44:47], v[96:99], v[104:107], v[44:47]
    ds_read_b64_tr_b16 v[116:117], v29 offset:16384
    v_mfma_f32_16x16x32_bf16 v[48:51], v[92:95], v[104:107], v[48:51]
    ds_read_b64_tr_b16 v[118:119], v29 offset:16896
    v_mfma_f32_16x16x32_bf16 v[48:51], v[96:99], v[108:111], v[48:51]
    s_waitcnt lgkmcnt(4)
    v_mfma_f32_16x16x32_bf16 v[52:55], v[92:95], v[108:111], v[52:55]
    s_barrier
    ds_read_b64_tr_b16 v[124:125], v27 offset:20480
    v_mfma_f32_16x16x32_bf16 v[52:55], v[96:99], v[100:103], v[52:55]
    ds_read_b64_tr_b16 v[126:127], v27 offset:20992
    v_mfma_f32_16x16x32_bf16 v[56:59], v[92:95], v[100:103], v[56:59]
    ds_read_b128 v[84:87], v16 offset:18432
    v_mfma_f32_16x16x32_bf16 v[56:59], v[96:99], v[112:115], v[56:59]
    ds_read_b64_tr_b16 v[76:77], v27 offset:24576
    s_waitcnt lgkmcnt(4)
    v_mfma_f32_16x16x32_bf16 v[60:63], v[120:123], v[88:91], v[60:63]
    ds_read_b64_tr_b16 v[78:79], v27 offset:25088
    v_mfma_f32_16x16x32_bf16 v[60:63], v[116:119], v[104:107], v[60:63]
    ds_read_b128 v[80:83], v16 offset:22528
    v_mfma_f32_16x16x32_bf16 v[64:67], v[120:123], v[104:107], v[64:67]
    ds_read_b128 v[92:95], v16 offset:27648
    v_mfma_f32_16x16x32_bf16 v[64:67], v[116:119], v[108:111], v[64:67]
    v_mfma_f32_16x16x32_bf16 v[68:71], v[120:123], v[108:111], v[68:71]
    v_mfma_f32_16x16x32_bf16 v[68:71], v[116:119], v[100:103], v[68:71]
    ds_read_b128 v[96:99], v16 offset:31744
    v_mfma_f32_16x16x32_bf16 v[72:75], v[120:123], v[100:103], v[72:75]
    ds_read_b128 v[88:91], v18 offset:18432
    v_mfma_f32_16x16x32_bf16 v[72:75], v[116:119], v[112:115], v[72:75]
    ds_read_b64_tr_b16 v[104:105], v29 offset:20480
    s_waitcnt lgkmcnt(3)
    v_mfma_f32_16x16x32_bf16 v[44:47], v[124:127], v[84:87], v[44:47]
    ds_read_b64_tr_b16 v[106:107], v29 offset:20992
    v_mfma_f32_16x16x32_bf16 v[44:47], v[76:79], v[80:83], v[44:47]
    ds_read_b64_tr_b16 v[108:109], v29 offset:24576
    v_mfma_f32_16x16x32_bf16 v[48:51], v[124:127], v[80:83], v[48:51]
    ds_read_b64_tr_b16 v[110:111], v29 offset:25088
    v_mfma_f32_16x16x32_bf16 v[48:51], v[76:79], v[92:95], v[48:51]
    s_waitcnt lgkmcnt(4)
    v_mfma_f32_16x16x32_bf16 v[52:55], v[124:127], v[92:95], v[52:55]
    v_mfma_f32_16x16x32_bf16 v[52:55], v[76:79], v[96:99], v[52:55]
    v_mfma_f32_16x16x32_bf16 v[56:59], v[124:127], v[96:99], v[56:59]
    v_mfma_f32_16x16x32_bf16 v[56:59], v[76:79], v[88:91], v[56:59]
    ds_read_b64_tr_b16 v[100:101], v27 offset:28672
    s_waitcnt lgkmcnt(1)
    v_mfma_f32_16x16x32_bf16 v[60:63], v[104:107], v[84:87], v[60:63]
    ds_read_b64_tr_b16 v[102:103], v27 offset:29184
    v_mfma_f32_16x16x32_bf16 v[60:63], v[108:111], v[80:83], v[60:63]
    ds_read_b64_tr_b16 v[120:121], v27 offset:32768
    v_mfma_f32_16x16x32_bf16 v[64:67], v[104:107], v[80:83], v[64:67]
    ds_read_b64_tr_b16 v[122:123], v27 offset:33280
    v_mfma_f32_16x16x32_bf16 v[64:67], v[108:111], v[92:95], v[64:67]
    v_mfma_f32_16x16x32_bf16 v[68:71], v[104:107], v[92:95], v[68:71]
    v_mfma_f32_16x16x32_bf16 v[68:71], v[108:111], v[96:99], v[68:71]
    ds_read_b128 v[112:115], v20 offset:18432
    v_mfma_f32_16x16x32_bf16 v[72:75], v[104:107], v[96:99], v[72:75]
    ds_read_b128 v[116:119], v18 offset:27648
    v_mfma_f32_16x16x32_bf16 v[72:75], v[108:111], v[88:91], v[72:75]
    ds_read_b64_tr_b16 v[124:125], v29 offset:28672
    s_waitcnt lgkmcnt(3)
    v_mfma_f32_16x16x32_bf16 v[44:47], v[100:103], v[92:95], v[44:47]
    ds_read_b64_tr_b16 v[126:127], v29 offset:29184
    v_mfma_f32_16x16x32_bf16 v[44:47], v[120:123], v[96:99], v[44:47]
    ds_read_b64_tr_b16 v[76:77], v29 offset:32768
    v_mfma_f32_16x16x32_bf16 v[48:51], v[100:103], v[96:99], v[48:51]
    ds_read_b64_tr_b16 v[78:79], v29 offset:33280
    v_mfma_f32_16x16x32_bf16 v[48:51], v[120:123], v[88:91], v[48:51]
    s_waitcnt lgkmcnt(4)
    v_mfma_f32_16x16x32_bf16 v[52:55], v[100:103], v[88:91], v[52:55]
    v_mfma_f32_16x16x32_bf16 v[52:55], v[120:123], v[112:115], v[52:55]
    v_mfma_f32_16x16x32_bf16 v[56:59], v[100:103], v[112:115], v[56:59]
    v_mfma_f32_16x16x32_bf16 v[56:59], v[120:123], v[116:119], v[56:59]
    s_barrier
    ds_read_b64_tr_b16 v[84:85], v27 offset:36864
    s_waitcnt lgkmcnt(1)
    v_mfma_f32_16x16x32_bf16 v[60:63], v[124:127], v[92:95], v[60:63]
    ds_read_b64_tr_b16 v[86:87], v27 offset:37376
    v_mfma_f32_16x16x32_bf16 v[60:63], v[76:79], v[96:99], v[60:63]
    ds_read_b64_tr_b16 v[80:81], v27 offset:40960
    v_mfma_f32_16x16x32_bf16 v[64:67], v[124:127], v[96:99], v[64:67]
    ds_read_b64_tr_b16 v[82:83], v27 offset:41472
    v_mfma_f32_16x16x32_bf16 v[64:67], v[76:79], v[88:91], v[64:67]
    v_mfma_f32_16x16x32_bf16 v[68:71], v[124:127], v[88:91], v[68:71]
    ds_read_b128 v[104:107], v20 offset:27648
    v_mfma_f32_16x16x32_bf16 v[68:71], v[76:79], v[112:115], v[68:71]
    ds_read_b128 v[108:111], v22 offset:18432
    v_mfma_f32_16x16x32_bf16 v[72:75], v[124:127], v[112:115], v[72:75]
    ds_read_b64_tr_b16 v[100:101], v29 offset:36864
    v_mfma_f32_16x16x32_bf16 v[72:75], v[76:79], v[116:119], v[72:75]
    ds_read_b64_tr_b16 v[102:103], v29 offset:37376
    s_waitcnt lgkmcnt(4)
    v_mfma_f32_16x16x32_bf16 v[44:47], v[84:87], v[88:91], v[44:47]
    ds_read_b64_tr_b16 v[120:121], v29 offset:40960
    v_mfma_f32_16x16x32_bf16 v[44:47], v[80:83], v[112:115], v[44:47]
    ds_read_b64_tr_b16 v[122:123], v29 offset:41472
    v_mfma_f32_16x16x32_bf16 v[48:51], v[84:87], v[112:115], v[48:51]
    ds_read_b128 v[92:95], v24 offset:18432
    v_mfma_f32_16x16x32_bf16 v[48:51], v[80:83], v[116:119], v[48:51]
    ds_read_b64_tr_b16 a[0:1], v26 offset:0
    s_waitcnt lgkmcnt(6)
    v_mfma_f32_16x16x32_bf16 v[52:55], v[84:87], v[116:119], v[52:55]
    ds_read_b64_tr_b16 a[2:3], v26 offset:512
    v_mfma_f32_16x16x32_bf16 v[52:55], v[80:83], v[104:107], v[52:55]
    ds_read_b128 v[96:99], v17 offset:18432
    v_mfma_f32_16x16x32_bf16 v[56:59], v[84:87], v[104:107], v[56:59]
    ds_read_b128 v[124:127], v17 offset:22528
    v_mfma_f32_16x16x32_bf16 v[56:59], v[80:83], v[108:111], v[56:59]
    ds_read_b128 v[76:79], v17 offset:27648
    s_waitcnt lgkmcnt(6)
    v_mfma_f32_16x16x32_bf16 v[60:63], v[100:103], v[88:91], v[60:63]
    s_barrier
    ds_read_b64_tr_b16 a[4:5], v26 offset:4096
    v_mfma_f32_16x16x32_bf16 v[60:63], v[120:123], v[112:115], v[60:63]
    ds_read_b64_tr_b16 v[84:85], v28 offset:0
    ds_read_b64_tr_b16 a[6:7], v26 offset:4608
    v_mfma_f32_16x16x32_bf16 v[64:67], v[100:103], v[112:115], v[64:67]
    ds_read_b64_tr_b16 v[86:87], v28 offset:512
    ds_read_b128 v[80:83], v17 offset:31744
    v_mfma_f32_16x16x32_bf16 v[64:67], v[120:123], v[116:119], v[64:67]
    ds_read_b64_tr_b16 v[88:89], v28 offset:4096
    ds_read_b128 v[112:115], v19 offset:18432
    v_mfma_f32_16x16x32_bf16 v[68:71], v[100:103], v[116:119], v[68:71]
    ds_read_b64_tr_b16 v[90:91], v28 offset:4608
    ds_read_b64_tr_b16 a[8:9], v26 offset:8192
    v_mfma_f32_16x16x32_bf16 v[68:71], v[120:123], v[104:107], v[68:71]
    ds_read_b64_tr_b16 a[68:69], v28 offset:8192
    ds_read_b64_tr_b16 a[10:11], v26 offset:8704
    v_mfma_f32_16x16x32_bf16 v[72:75], v[100:103], v[104:107], v[72:75]
    ds_read_b64_tr_b16 a[70:71], v28 offset:8704
    ds_read_b64_tr_b16 v[100:101], v28 offset:16384
    v_mfma_f32_16x16x32_bf16 v[72:75], v[120:123], v[108:111], v[72:75]
    ds_read_b64_tr_b16 v[102:103], v28 offset:16896
    s_waitcnt lgkmcnt(10)
    v_mfma_f32_16x16x32_bf16 v[60:63], v[84:87], v[116:119], v[60:63]
    ds_read_b64_tr_b16 a[12:13], v26 offset:12288
    v_mfma_f32_16x16x32_bf16 v[64:67], v[84:87], v[104:107], v[64:67]
    ds_read_b64_tr_b16 a[14:15], v26 offset:12800
    v_mfma_f32_16x16x32_bf16 v[68:71], v[84:87], v[108:111], v[68:71]
    ds_read_b128 v[120:123], v21 offset:18432
    v_mfma_f32_16x16x32_bf16 v[72:75], v[84:87], v[92:95], v[72:75]
    ds_read_b128 v[116:119], v19 offset:27648
    s_waitcnt lgkmcnt(6)
    v_mfma_f32_16x16x32_bf16 v[60:63], v[88:91], v[96:99], v[60:63]
    ds_read_b64_tr_b16 a[16:17], v26 offset:16384
    v_mfma_f32_16x16x32_bf16 v[60:63], a[68:71], v[124:127], v[60:63]
    ds_read_b64_tr_b16 v[104:105], v28 offset:12288
    ds_read_b64_tr_b16 a[18:19], v26 offset:16896
    v_mfma_f32_16x16x32_bf16 v[64:67], v[88:91], v[124:127], v[64:67]
    ds_read_b64_tr_b16 v[106:107], v28 offset:12800
    s_barrier
    ds_read_b64_tr_b16 v[108:109], v28 offset:24576
    v_mfma_f32_16x16x32_bf16 v[64:67], a[68:71], v[76:79], v[64:67]
    ds_read_b64_tr_b16 v[110:111], v28 offset:25088
    v_mfma_f32_16x16x32_bf16 v[68:71], v[88:91], v[76:79], v[68:71]
    ds_read_b64_tr_b16 a[20:21], v26 offset:20480
    v_mfma_f32_16x16x32_bf16 v[68:71], a[68:71], v[80:83], v[68:71]
    ds_read_b64_tr_b16 a[22:23], v26 offset:20992
    v_mfma_f32_16x16x32_bf16 v[72:75], v[88:91], v[80:83], v[72:75]
    ds_read_b128 v[92:95], v21 offset:27648
    v_mfma_f32_16x16x32_bf16 v[72:75], a[68:71], v[112:115], v[72:75]
    ds_read_b128 v[84:87], v23 offset:18432
    s_waitcnt lgkmcnt(6)
    v_mfma_f32_16x16x32_bf16 v[60:63], v[104:107], v[76:79], v[60:63]
    ds_read_b64_tr_b16 a[24:25], v26 offset:24576
    v_mfma_f32_16x16x32_bf16 v[60:63], v[100:103], v[80:83], v[60:63]
    ds_read_b64_tr_b16 v[96:97], v28 offset:20480
    ds_read_b64_tr_b16 a[26:27], v26 offset:25088
    v_mfma_f32_16x16x32_bf16 v[64:67], v[104:107], v[80:83], v[64:67]
    ds_read_b64_tr_b16 v[98:99], v28 offset:20992
    ds_read_b128 v[124:127], v25 offset:18432
    v_mfma_f32_16x16x32_bf16 v[64:67], v[100:103], v[112:115], v[64:67]
    ds_read_b64_tr_b16 a[28:29], v26 offset:28672
    v_mfma_f32_16x16x32_bf16 v[68:71], v[104:107], v[112:115], v[68:71]
    ds_read_b64_tr_b16 a[30:31], v26 offset:29184
    v_mfma_f32_16x16x32_bf16 v[68:71], v[100:103], v[120:123], v[68:71]
    ds_read_b128 v[88:91], v16 offset:36864
    v_mfma_f32_16x16x32_bf16 v[72:75], v[104:107], v[120:123], v[72:75]
    ds_read_b128 v[76:79], v16 offset:40960
    v_mfma_f32_16x16x32_bf16 v[72:75], v[100:103], v[116:119], v[72:75]
    ds_read_b128 v[80:83], v16 offset:46080
    s_waitcnt lgkmcnt(6)
    v_mfma_f32_16x16x32_bf16 v[60:63], v[96:99], v[112:115], v[60:63]
    s_barrier
    ds_read_b64_tr_b16 a[32:33], v26 offset:32768
    v_mfma_f32_16x16x32_bf16 v[60:63], v[108:111], v[120:123], v[60:63]
    ds_read_b64_tr_b16 v[104:105], v28 offset:28672
    ds_read_b64_tr_b16 a[34:35], v26 offset:33280
    v_mfma_f32_16x16x32_bf16 v[64:67], v[96:99], v[120:123], v[64:67]
    ds_read_b64_tr_b16 v[106:107], v28 offset:29184
    ds_read_b128 v[100:103], v16 offset:50176
    v_mfma_f32_16x16x32_bf16 v[64:67], v[108:111], v[116:119], v[64:67]
    ds_read_b64_tr_b16 v[112:113], v28 offset:32768
    ds_read_b128 v[120:123], v18 offset:36864
    v_mfma_f32_16x16x32_bf16 v[68:71], v[96:99], v[116:119], v[68:71]
    ds_read_b64_tr_b16 v[114:115], v28 offset:33280
    ds_read_b64_tr_b16 a[36:37], v26 offset:36864
    v_mfma_f32_16x16x32_bf16 v[68:71], v[108:111], v[92:95], v[68:71]
    ds_read_b64_tr_b16 a[68:69], v28 offset:36864
    ds_read_b64_tr_b16 a[38:39], v26 offset:37376
    v_mfma_f32_16x16x32_bf16 v[72:75], v[96:99], v[92:95], v[72:75]
    ds_read_b64_tr_b16 a[70:71], v28 offset:37376
    ds_read_b64_tr_b16 v[96:97], v29 offset:0
    v_mfma_f32_16x16x32_bf16 v[72:75], v[108:111], v[84:87], v[72:75]
    ds_read_b64_tr_b16 v[98:99], v29 offset:512
    s_waitcnt lgkmcnt(10)
    v_mfma_f32_16x16x32_bf16 v[60:63], v[104:107], v[116:119], v[60:63]
    ds_read_b64_tr_b16 a[40:41], v26 offset:40960
    v_mfma_f32_16x16x32_bf16 v[64:67], v[104:107], v[92:95], v[64:67]
    ds_read_b64_tr_b16 a[42:43], v26 offset:41472
    v_mfma_f32_16x16x32_bf16 v[68:71], v[104:107], v[84:87], v[68:71]
    ds_read_b128 v[108:111], v20 offset:36864
    v_mfma_f32_16x16x32_bf16 v[72:75], v[104:107], v[124:127], v[72:75]
    ds_read_b128 v[116:119], v18 offset:46080
    s_waitcnt lgkmcnt(6)
    v_mfma_f32_16x16x32_bf16 v[60:63], v[112:115], v[88:91], v[60:63]
    ds_read_b64_tr_b16 a[44:45], v27 offset:0
    v_mfma_f32_16x16x32_bf16 v[60:63], a[68:71], v[76:79], v[60:63]
    ds_read_b64_tr_b16 v[92:93], v28 offset:40960
    ds_read_b64_tr_b16 a[46:47], v27 offset:512
    v_mfma_f32_16x16x32_bf16 v[64:67], v[112:115], v[76:79], v[64:67]
    ds_read_b64_tr_b16 v[94:95], v28 offset:41472
    s_barrier
    ds_read_b64_tr_b16 v[84:85], v29 offset:8192
    v_mfma_f32_16x16x32_bf16 v[64:67], a[68:71], v[80:83], v[64:67]
    ds_read_b64_tr_b16 v[86:87], v29 offset:8704
    v_mfma_f32_16x16x32_bf16 v[68:71], v[112:115], v[80:83], v[68:71]
    ds_read_b64_tr_b16 a[48:49], v27 offset:4096
    v_mfma_f32_16x16x32_bf16 v[68:71], a[68:71], v[100:103], v[68:71]
    ds_read_b64_tr_b16 a[50:51], v27 offset:4608
    v_mfma_f32_16x16x32_bf16 v[72:75], v[112:115], v[100:103], v[72:75]
    ds_read_b128 v[124:127], v20 offset:46080
    v_mfma_f32_16x16x32_bf16 v[72:75], a[68:71], v[120:123], v[72:75]
    ds_read_b128 v[104:107], v22 offset:36864
    s_waitcnt lgkmcnt(6)
    v_mfma_f32_16x16x32_bf16 v[60:63], v[92:95], v[80:83], v[60:63]
    ds_read_b64_tr_b16 a[52:53], v27 offset:8192
    v_mfma_f32_16x16x32_bf16 v[60:63], v[96:99], v[100:103], v[60:63]
    ds_read_b64_tr_b16 v[88:89], v29 offset:4096
    ds_read_b64_tr_b16 a[54:55], v27 offset:8704
    v_mfma_f32_16x16x32_bf16 v[64:67], v[92:95], v[100:103], v[64:67]
    ds_read_b64_tr_b16 v[90:91], v29 offset:4608
    ds_read_b64_tr_b16 v[76:77], v29 offset:12288
    v_mfma_f32_16x16x32_bf16 v[64:67], v[96:99], v[120:123], v[64:67]
    ds_read_b64_tr_b16 v[78:79], v29 offset:12800
    v_mfma_f32_16x16x32_bf16 v[68:71], v[92:95], v[120:123], v[68:71]
    ds_read_b64_tr_b16 v[112:113], v29 offset:16384
    v_mfma_f32_16x16x32_bf16 v[68:71], v[96:99], v[108:111], v[68:71]
    ds_read_b64_tr_b16 v[114:115], v29 offset:16896
    v_mfma_f32_16x16x32_bf16 v[72:75], v[92:95], v[108:111], v[72:75]
    ds_read_b64_tr_b16 a[56:57], v27 offset:12288
    v_mfma_f32_16x16x32_bf16 v[72:75], v[96:99], v[116:119], v[72:75]
    ds_read_b64_tr_b16 a[58:59], v27 offset:12800
    s_waitcnt lgkmcnt(6)
    v_mfma_f32_16x16x32_bf16 v[60:63], v[88:91], v[120:123], v[60:63]
    ds_read_b128 v[80:83], v24 offset:36864
    v_mfma_f32_16x16x32_bf16 v[60:63], v[84:87], v[108:111], v[60:63]
    ds_read_b128 v[100:103], v22 offset:46080
    v_mfma_f32_16x16x32_bf16 v[64:67], v[88:91], v[108:111], v[64:67]
    ds_read_b64_tr_b16 a[60:61], v27 offset:16384
    v_mfma_f32_16x16x32_bf16 v[64:67], v[84:87], v[116:119], v[64:67]
    ds_read_b64_tr_b16 a[62:63], v27 offset:16896
    v_mfma_f32_16x16x32_bf16 v[68:71], v[88:91], v[116:119], v[68:71]
    s_barrier
    ds_read_b64_tr_b16 v[92:93], v29 offset:20480
    v_mfma_f32_16x16x32_bf16 v[68:71], v[84:87], v[124:127], v[68:71]
    ds_read_b64_tr_b16 v[94:95], v29 offset:20992
    v_mfma_f32_16x16x32_bf16 v[72:75], v[88:91], v[124:127], v[72:75]
    ds_read_b128 v[96:99], v17 offset:36864
    v_mfma_f32_16x16x32_bf16 v[72:75], v[84:87], v[104:107], v[72:75]
    ds_read_b64_tr_b16 v[120:121], v29 offset:24576
    s_waitcnt lgkmcnt(10)
    v_mfma_f32_16x16x32_bf16 v[60:63], v[76:79], v[116:119], v[60:63]
    ds_read_b64_tr_b16 v[122:123], v29 offset:25088
    v_mfma_f32_16x16x32_bf16 v[60:63], v[112:115], v[124:127], v[60:63]
    ds_read_b128 v[108:111], v17 offset:40960
    v_mfma_f32_16x16x32_bf16 v[64:67], v[76:79], v[124:127], v[64:67]
    ds_read_b128 v[88:91], v17 offset:46080
    v_mfma_f32_16x16x32_bf16 v[64:67], v[112:115], v[104:107], v[64:67]
    s_waitcnt lgkmcnt(9)
    v_mfma_f32_16x16x32_bf16 v[68:71], v[76:79], v[104:107], v[68:71]
    v_mfma_f32_16x16x32_bf16 v[68:71], v[112:115], v[80:83], v[68:71]
    ds_read_b128 v[84:87], v17 offset:50176
    v_mfma_f32_16x16x32_bf16 v[72:75], v[76:79], v[80:83], v[72:75]
    ds_read_b128 v[116:119], v19 offset:36864
    v_mfma_f32_16x16x32_bf16 v[72:75], v[112:115], v[100:103], v[72:75]
    ds_read_b64_tr_b16 v[124:125], v29 offset:28672
    s_waitcnt lgkmcnt(3)
    v_mfma_f32_16x16x32_bf16 v[60:63], v[92:95], v[96:99], v[60:63]
    ds_read_b64_tr_b16 v[126:127], v29 offset:29184
    v_mfma_f32_16x16x32_bf16 v[60:63], v[120:123], v[108:111], v[60:63]
    ds_read_b64_tr_b16 v[104:105], v29 offset:32768
    v_mfma_f32_16x16x32_bf16 v[64:67], v[92:95], v[108:111], v[64:67]
    ds_read_b64_tr_b16 v[106:107], v29 offset:33280
    v_mfma_f32_16x16x32_bf16 v[64:67], v[120:123], v[88:91], v[64:67]
    s_waitcnt lgkmcnt(4)
    v_mfma_f32_16x16x32_bf16 v[68:71], v[92:95], v[88:91], v[68:71]
    v_mfma_f32_16x16x32_bf16 v[68:71], v[120:123], v[84:87], v[68:71]
    ds_read_b128 v[80:83], v21 offset:36864
    v_mfma_f32_16x16x32_bf16 v[72:75], v[92:95], v[84:87], v[72:75]
    ds_read_b128 v[76:79], v19 offset:46080
    v_mfma_f32_16x16x32_bf16 v[72:75], v[120:123], v[116:119], v[72:75]
    s_barrier
    ds_read_b64_tr_b16 v[100:101], v29 offset:36864
    s_waitcnt lgkmcnt(3)
    v_mfma_f32_16x16x32_bf16 v[60:63], v[124:127], v[88:91], v[60:63]
    ds_read_b64_tr_b16 v[102:103], v29 offset:37376
    v_mfma_f32_16x16x32_bf16 v[60:63], v[104:107], v[84:87], v[60:63]
    ds_read_b64_tr_b16 v[112:113], v29 offset:40960
    v_mfma_f32_16x16x32_bf16 v[64:67], v[124:127], v[84:87], v[64:67]
    ds_read_b64_tr_b16 v[114:115], v29 offset:41472
    v_mfma_f32_16x16x32_bf16 v[64:67], v[104:107], v[116:119], v[64:67]
    s_waitcnt lgkmcnt(4)
    v_mfma_f32_16x16x32_bf16 v[68:71], v[124:127], v[116:119], v[68:71]
    ds_read_b128 v[96:99], v21 offset:46080
    v_mfma_f32_16x16x32_bf16 v[68:71], v[104:107], v[80:83], v[68:71]
    ds_read_b128 v[108:111], v23 offset:36864
    v_mfma_f32_16x16x32_bf16 v[72:75], v[124:127], v[80:83], v[72:75]
    ds_read_b64_tr_b16 v[92:93], v28 offset:0
    v_mfma_f32_16x16x32_bf16 v[72:75], v[104:107], v[76:79], v[72:75]
    ds_read_b64_tr_b16 v[94:95], v28 offset:512
    s_waitcnt lgkmcnt(4)
    v_mfma_f32_16x16x32_bf16 v[60:63], v[100:103], v[116:119], v[60:63]
    ds_read_b64_tr_b16 v[120:121], v28 offset:4096
    v_mfma_f32_16x16x32_bf16 v[60:63], v[112:115], v[80:83], v[60:63]
    ds_read_b64_tr_b16 v[122:123], v28 offset:4608
    v_mfma_f32_16x16x32_bf16 v[64:67], v[100:103], v[80:83], v[64:67]
    ds_read_b128 v[88:91], v25 offset:36864
    v_mfma_f32_16x16x32_bf16 v[64:67], v[112:115], v[76:79], v[64:67]
    ds_read_b128 v[84:87], v23 offset:46080
    s_waitcnt lgkmcnt(6)
    v_mfma_f32_16x16x32_bf16 v[68:71], v[100:103], v[76:79], v[68:71]
    s_barrier
    ds_read_b64_tr_b16 v[124:125], v28 offset:8192
    v_mfma_f32_16x16x32_bf16 v[68:71], v[112:115], v[96:99], v[68:71]
    ds_read_b64_tr_b16 v[126:127], v28 offset:8704
    v_mfma_f32_16x16x32_bf16 v[72:75], v[100:103], v[96:99], v[72:75]
    ds_read_b128 v[104:107], v16 offset:55296
    v_mfma_f32_16x16x32_bf16 v[72:75], v[112:115], v[108:111], v[72:75]
    ds_read_b64_tr_b16 v[116:117], v28 offset:12288
    s_waitcnt lgkmcnt(6)
    v_mfma_f32_16x16x32_bf16 v[60:63], v[92:95], v[76:79], v[60:63]
    ds_read_b64_tr_b16 v[118:119], v28 offset:12800
    v_mfma_f32_16x16x32_bf16 v[60:63], v[120:123], v[96:99], v[60:63]
    ds_read_b128 v[80:83], v16 offset:59392
    v_mfma_f32_16x16x32_bf16 v[64:67], v[92:95], v[96:99], v[64:67]
    ds_read_b128 v[100:103], v16 offset:64512
    v_mfma_f32_16x16x32_bf16 v[64:67], v[120:123], v[108:111], v[64:67]
    s_waitcnt lgkmcnt(7)
    v_mfma_f32_16x16x32_bf16 v[68:71], v[92:95], v[108:111], v[68:71]
    v_mfma_f32_16x16x32_bf16 v[68:71], v[120:123], v[88:91], v[68:71]
    v_add_u32 v31, 36864, v16
    ds_read_b128 v[112:115], v31 offset:31744
    v_mfma_f32_16x16x32_bf16 v[72:75], v[92:95], v[88:91], v[72:75]
    ds_read_b128 v[76:79], v18 offset:55296
    v_mfma_f32_16x16x32_bf16 v[72:75], v[120:123], v[84:87], v[72:75]
    ds_read_b64_tr_b16 v[96:97], v28 offset:16384
    s_waitcnt lgkmcnt(3)
    v_mfma_f32_16x16x32_bf16 v[60:63], v[124:127], v[104:107], v[60:63]
    ds_read_b64_tr_b16 v[98:99], v28 offset:16896
    v_mfma_f32_16x16x32_bf16 v[60:63], v[116:119], v[80:83], v[60:63]
    ds_read_b64_tr_b16 v[108:109], v28 offset:20480
    v_mfma_f32_16x16x32_bf16 v[64:67], v[124:127], v[80:83], v[64:67]
    ds_read_b64_tr_b16 v[110:111], v28 offset:20992
    v_mfma_f32_16x16x32_bf16 v[64:67], v[116:119], v[100:103], v[64:67]
    s_waitcnt lgkmcnt(4)
    v_mfma_f32_16x16x32_bf16 v[68:71], v[124:127], v[100:103], v[68:71]
    v_mfma_f32_16x16x32_bf16 v[68:71], v[116:119], v[112:115], v[68:71]
    ds_read_b128 v[88:91], v20 offset:55296
    v_mfma_f32_16x16x32_bf16 v[72:75], v[124:127], v[112:115], v[72:75]
    ds_read_b128 v[92:95], v18 offset:64512
    v_mfma_f32_16x16x32_bf16 v[72:75], v[116:119], v[76:79], v[72:75]
    s_barrier
    ds_read_b64_tr_b16 v[84:85], v28 offset:24576
    s_waitcnt lgkmcnt(3)
    v_mfma_f32_16x16x32_bf16 v[60:63], v[96:99], v[100:103], v[60:63]
    ds_read_b64_tr_b16 v[86:87], v28 offset:25088
    v_mfma_f32_16x16x32_bf16 v[60:63], v[108:111], v[112:115], v[60:63]
    ds_read_b64_tr_b16 v[120:121], v28 offset:28672
    v_mfma_f32_16x16x32_bf16 v[64:67], v[96:99], v[112:115], v[64:67]
    ds_read_b64_tr_b16 v[122:123], v28 offset:29184
    v_mfma_f32_16x16x32_bf16 v[64:67], v[108:111], v[76:79], v[64:67]
    ds_read_b128 v[104:107], v20 offset:64512
    s_waitcnt lgkmcnt(5)
    v_mfma_f32_16x16x32_bf16 v[68:71], v[96:99], v[76:79], v[68:71]
    ds_read_b128 v[80:83], v22 offset:55296
    v_mfma_f32_16x16x32_bf16 v[68:71], v[108:111], v[88:91], v[68:71]
    ds_read_b64_tr_b16 v[124:125], v28 offset:32768
    v_mfma_f32_16x16x32_bf16 v[72:75], v[96:99], v[88:91], v[72:75]
    ds_read_b64_tr_b16 v[126:127], v28 offset:33280
    v_mfma_f32_16x16x32_bf16 v[72:75], v[108:111], v[92:95], v[72:75]
    ds_read_b128 v[116:119], v24 offset:55296
    s_waitcnt lgkmcnt(5)
    v_mfma_f32_16x16x32_bf16 v[60:63], v[84:87], v[76:79], v[60:63]
    s_barrier
    ds_read_b64_tr_b16 v[100:101], v28 offset:36864
    v_mfma_f32_16x16x32_bf16 v[60:63], v[120:123], v[88:91], v[60:63]
    ds_read_b64_tr_b16 v[102:103], v28 offset:37376
    v_mfma_f32_16x16x32_bf16 v[64:67], v[84:87], v[88:91], v[64:67]
    ds_read_b128 v[112:115], v17 offset:55296
    v_mfma_f32_16x16x32_bf16 v[64:67], v[120:123], v[92:95], v[64:67]
    ds_read_b64_tr_b16 v[96:97], v28 offset:40960
    s_waitcnt lgkmcnt(7)
    v_mfma_f32_16x16x32_bf16 v[68:71], v[84:87], v[92:95], v[68:71]
    ds_read_b64_tr_b16 v[98:99], v28 offset:41472
    v_mfma_f32_16x16x32_bf16 v[68:71], v[120:123], v[104:107], v[68:71]
    ds_read_b128 v[108:111], v17 offset:59392
    v_mfma_f32_16x16x32_bf16 v[72:75], v[84:87], v[104:107], v[72:75]
    ds_read_b128 v[76:79], v17 offset:64512
    v_mfma_f32_16x16x32_bf16 v[72:75], v[120:123], v[80:83], v[72:75]
    s_waitcnt lgkmcnt(7)
    v_mfma_f32_16x16x32_bf16 v[60:63], v[124:127], v[92:95], v[60:63]
    v_mfma_f32_16x16x32_bf16 v[64:67], v[124:127], v[104:107], v[64:67]
    v_add_u32 v31, 36864, v17
    ds_read_b128 v[88:91], v31 offset:31744
    v_mfma_f32_16x16x32_bf16 v[68:71], v[124:127], v[80:83], v[68:71]
    ds_read_b128 v[84:87], v19 offset:55296
    v_mfma_f32_16x16x32_bf16 v[72:75], v[124:127], v[116:119], v[72:75]
    ds_read_b64_tr_b16 v[120:121], v29 offset:0
    s_waitcnt lgkmcnt(3)
    v_mfma_f32_16x16x32_bf16 v[60:63], v[100:103], v[112:115], v[60:63]
    ds_read_b64_tr_b16 v[122:123], v29 offset:512
    v_mfma_f32_16x16x32_bf16 v[60:63], v[96:99], v[108:111], v[60:63]
    ds_read_b64_tr_b16 v[92:93], v29 offset:4096
    v_mfma_f32_16x16x32_bf16 v[64:67], v[100:103], v[108:111], v[64:67]
    ds_read_b64_tr_b16 v[94:95], v29 offset:4608
    v_mfma_f32_16x16x32_bf16 v[64:67], v[96:99], v[76:79], v[64:67]
    s_waitcnt lgkmcnt(4)
    v_mfma_f32_16x16x32_bf16 v[68:71], v[100:103], v[76:79], v[68:71]
    v_mfma_f32_16x16x32_bf16 v[68:71], v[96:99], v[88:91], v[68:71]
    ds_read_b128 v[104:107], v21 offset:55296
    v_mfma_f32_16x16x32_bf16 v[72:75], v[100:103], v[88:91], v[72:75]
    ds_read_b128 v[80:83], v19 offset:64512
    v_mfma_f32_16x16x32_bf16 v[72:75], v[96:99], v[84:87], v[72:75]
    s_barrier
    ds_read_b64_tr_b16 v[116:117], v29 offset:8192
    s_waitcnt lgkmcnt(3)
    v_mfma_f32_16x16x32_bf16 v[60:63], v[120:123], v[76:79], v[60:63]
    ds_read_b64_tr_b16 v[118:119], v29 offset:8704
    v_mfma_f32_16x16x32_bf16 v[60:63], v[92:95], v[88:91], v[60:63]
    ds_read_b64_tr_b16 v[124:125], v29 offset:12288
    v_mfma_f32_16x16x32_bf16 v[64:67], v[120:123], v[88:91], v[64:67]
    ds_read_b64_tr_b16 v[126:127], v29 offset:12800
    v_mfma_f32_16x16x32_bf16 v[64:67], v[92:95], v[84:87], v[64:67]
    s_waitcnt lgkmcnt(4)
    v_mfma_f32_16x16x32_bf16 v[68:71], v[120:123], v[84:87], v[68:71]
    v_mfma_f32_16x16x32_bf16 v[68:71], v[92:95], v[104:107], v[68:71]
    ds_read_b128 v[112:115], v21 offset:64512
    v_mfma_f32_16x16x32_bf16 v[72:75], v[120:123], v[104:107], v[72:75]
    ds_read_b128 v[108:111], v23 offset:55296
    v_mfma_f32_16x16x32_bf16 v[72:75], v[92:95], v[80:83], v[72:75]
    s_waitcnt lgkmcnt(2)
    v_mfma_f32_16x16x32_bf16 v[60:63], v[116:119], v[84:87], v[60:63]
    ds_read_b64_tr_b16 v[100:101], v29 offset:16384
    v_mfma_f32_16x16x32_bf16 v[60:63], v[124:127], v[104:107], v[60:63]
    ds_read_b64_tr_b16 v[102:103], v29 offset:16896
    v_mfma_f32_16x16x32_bf16 v[64:67], v[116:119], v[104:107], v[64:67]
    ds_read_b128 v[96:99], v25 offset:55296
    v_mfma_f32_16x16x32_bf16 v[64:67], v[124:127], v[80:83], v[64:67]
    ds_read_b128 v[76:79], v18 offset:27648
    s_waitcnt lgkmcnt(4)
    v_mfma_f32_16x16x32_bf16 v[68:71], v[116:119], v[80:83], v[68:71]
    ds_read_b128 v[88:91], v20 offset:27648
    v_mfma_f32_16x16x32_bf16 v[68:71], v[124:127], v[112:115], v[68:71]
    ds_read_b128 v[120:123], v22 offset:18432
    v_mfma_f32_16x16x32_bf16 v[72:75], v[116:119], v[112:115], v[72:75]
    ds_read_b128 v[92:95], v24 offset:18432
    v_mfma_f32_16x16x32_bf16 v[72:75], v[124:127], v[108:111], v[72:75]
    s_waitcnt lgkmcnt(4)
    v_mfma_f32_16x16x32_bf16 v[60:63], v[100:103], v[80:83], v[60:63]
    ds_read_b128 v[84:87], v17 offset:18432
    v_mfma_f32_16x16x32_bf16 v[64:67], v[100:103], v[112:115], v[64:67]
    ds_read_b128 v[104:107], v17 offset:22528
    v_mfma_f32_16x16x32_bf16 v[68:71], v[100:103], v[108:111], v[68:71]
    ds_read_b128 v[116:119], v17 offset:27648
    v_mfma_f32_16x16x32_bf16 v[72:75], v[100:103], v[96:99], v[72:75]
    s_waitcnt lgkmcnt(3)
    v_mfma_f32_16x16x32_bf16 v[44:47], a[0:3], v[76:79], v[44:47]
    v_mfma_f32_16x16x32_bf16 v[48:51], a[0:3], v[88:91], v[48:51]
    ds_read_b128 v[124:127], v17 offset:31744
    v_mfma_f32_16x16x32_bf16 v[52:55], a[0:3], v[120:123], v[52:55]
    ds_read_b128 v[80:83], v19 offset:18432
    v_mfma_f32_16x16x32_bf16 v[56:59], a[0:3], v[92:95], v[56:59]
    s_waitcnt lgkmcnt(2)
    v_mfma_f32_16x16x32_bf16 v[44:47], a[4:7], v[84:87], v[44:47]
    v_cvt_pk_bf16_f32 v60, v60, v61
    v_cvt_pk_bf16_f32 v62, v62, v63
    v_mfma_f32_16x16x32_bf16 v[44:47], a[8:11], v[104:107], v[44:47]
    v_mov_b32 v61, v2
    v_mov_b32 v63, v2
    v_mfma_f32_16x16x32_bf16 v[48:51], a[4:7], v[104:107], v[48:51]
    buffer_store_dwordx4 v[60:63], v15, s[32:35], s44 offen offset:0 sc1
    v_mfma_f32_16x16x32_bf16 v[48:51], a[8:11], v[116:119], v[48:51]
    s_waitcnt lgkmcnt(0)
    v_mfma_f32_16x16x32_bf16 v[52:55], a[4:7], v[116:119], v[52:55]
    v_cvt_pk_bf16_f32 v64, v64, v65
    v_cvt_pk_bf16_f32 v66, v66, v67
    v_mfma_f32_16x16x32_bf16 v[52:55], a[8:11], v[124:127], v[52:55]
    ds_read_b128 v[112:115], v21 offset:18432
    v_mov_b32 v65, v2
    v_mov_b32 v67, v2
    v_mfma_f32_16x16x32_bf16 v[56:59], a[4:7], v[124:127], v[56:59]
    ds_read_b128 v[108:111], v19 offset:27648
    buffer_store_dwordx4 v[64:67], v15, s[32:35], s44 offen offset:1024 sc1
    v_mfma_f32_16x16x32_bf16 v[56:59], a[8:11], v[80:83], v[56:59]
    v_mfma_f32_16x16x32_bf16 v[44:47], a[12:15], v[116:119], v[44:47]
    v_cvt_pk_bf16_f32 v68, v68, v69
    v_cvt_pk_bf16_f32 v70, v70, v71
    v_mfma_f32_16x16x32_bf16 v[44:47], a[16:19], v[124:127], v[44:47]
    v_mov_b32 v69, v2
    v_mov_b32 v71, v2
    v_mfma_f32_16x16x32_bf16 v[48:51], a[12:15], v[124:127], v[48:51]
    buffer_store_dwordx4 v[68:71], v15, s[32:35], s44 offen offset:2048 sc1
    v_mfma_f32_16x16x32_bf16 v[48:51], a[16:19], v[80:83], v[48:51]
    s_waitcnt lgkmcnt(0)
    v_mfma_f32_16x16x32_bf16 v[52:55], a[12:15], v[80:83], v[52:55]
    v_cvt_pk_bf16_f32 v72, v72, v73
    v_cvt_pk_bf16_f32 v74, v74, v75
    v_mfma_f32_16x16x32_bf16 v[52:55], a[16:19], v[112:115], v[52:55]
    ds_read_b128 v[96:99], v21 offset:27648
    v_mov_b32 v73, v2
    v_mov_b32 v75, v2
    v_mfma_f32_16x16x32_bf16 v[56:59], a[12:15], v[112:115], v[56:59]
    ds_read_b128 v[100:103], v23 offset:18432
    buffer_store_dwordx4 v[72:75], v15, s[32:35], s44 offen offset:3072 sc1
    v_mfma_f32_16x16x32_bf16 v[56:59], a[16:19], v[108:111], v[56:59]
    v_mfma_f32_16x16x32_bf16 v[44:47], a[20:23], v[80:83], v[44:47]
    v_mfma_f32_16x16x32_bf16 v[44:47], a[24:27], v[112:115], v[44:47]
    v_mfma_f32_16x16x32_bf16 v[48:51], a[20:23], v[112:115], v[48:51]
    ds_read_b128 v[76:79], v25 offset:18432
    v_mfma_f32_16x16x32_bf16 v[48:51], a[24:27], v[108:111], v[48:51]
    s_waitcnt lgkmcnt(1)
    v_mfma_f32_16x16x32_bf16 v[52:55], a[20:23], v[108:111], v[52:55]
    ds_read_b128 v[88:91], v16 offset:36864
    v_mfma_f32_16x16x32_bf16 v[52:55], a[24:27], v[96:99], v[52:55]
    ds_read_b128 v[120:123], v16 offset:40960
    v_mfma_f32_16x16x32_bf16 v[56:59], a[20:23], v[96:99], v[56:59]
    ds_read_b128 v[92:95], v16 offset:46080
    v_mfma_f32_16x16x32_bf16 v[56:59], a[24:27], v[100:103], v[56:59]
    s_waitcnt lgkmcnt(3)
    v_mfma_f32_16x16x32_bf16 v[44:47], a[28:31], v[108:111], v[44:47]
    v_mfma_f32_16x16x32_bf16 v[48:51], a[28:31], v[96:99], v[48:51]
    ds_read_b128 v[84:87], v16 offset:50176
    v_mfma_f32_16x16x32_bf16 v[52:55], a[28:31], v[100:103], v[52:55]
    ds_read_b128 v[104:107], v18 offset:36864
    v_mfma_f32_16x16x32_bf16 v[56:59], a[28:31], v[76:79], v[56:59]
    s_waitcnt lgkmcnt(2)
    v_mfma_f32_16x16x32_bf16 v[44:47], a[32:35], v[88:91], v[44:47]
    v_mfma_f32_16x16x32_bf16 v[44:47], a[36:39], v[120:123], v[44:47]
    v_mfma_f32_16x16x32_bf16 v[48:51], a[32:35], v[120:123], v[48:51]
    v_mfma_f32_16x16x32_bf16 v[48:51], a[36:39], v[92:95], v[48:51]
    s_waitcnt lgkmcnt(0)
    v_mfma_f32_16x16x32_bf16 v[52:55], a[32:35], v[92:95], v[52:55]
    v_mfma_f32_16x16x32_bf16 v[52:55], a[36:39], v[84:87], v[52:55]
    ds_read_b128 v[116:119], v20 offset:36864
    v_mfma_f32_16x16x32_bf16 v[56:59], a[32:35], v[84:87], v[56:59]
    ds_read_b128 v[124:127], v18 offset:46080
    v_mfma_f32_16x16x32_bf16 v[56:59], a[36:39], v[104:107], v[56:59]
    v_mfma_f32_16x16x32_bf16 v[44:47], a[40:43], v[92:95], v[44:47]
    v_mfma_f32_16x16x32_bf16 v[44:47], a[44:47], v[84:87], v[44:47]
    v_mfma_f32_16x16x32_bf16 v[48:51], a[40:43], v[84:87], v[48:51]
    v_mfma_f32_16x16x32_bf16 v[48:51], a[44:47], v[104:107], v[48:51]
    s_waitcnt lgkmcnt(0)
    v_mfma_f32_16x16x32_bf16 v[52:55], a[40:43], v[104:107], v[52:55]
    v_mfma_f32_16x16x32_bf16 v[52:55], a[44:47], v[116:119], v[52:55]
    ds_read_b128 v[80:83], v20 offset:46080
    v_mfma_f32_16x16x32_bf16 v[56:59], a[40:43], v[116:119], v[56:59]
    ds_read_b128 v[112:115], v22 offset:36864
    v_mfma_f32_16x16x32_bf16 v[56:59], a[44:47], v[124:127], v[56:59]
    v_mfma_f32_16x16x32_bf16 v[44:47], a[48:51], v[104:107], v[44:47]
    v_mfma_f32_16x16x32_bf16 v[44:47], a[52:55], v[116:119], v[44:47]
    v_mfma_f32_16x16x32_bf16 v[48:51], a[48:51], v[116:119], v[48:51]
    ds_read_b128 v[108:111], v24 offset:36864
    v_mfma_f32_16x16x32_bf16 v[48:51], a[52:55], v[124:127], v[48:51]
    ds_read_b128 v[96:99], v22 offset:46080
    s_waitcnt lgkmcnt(2)
    v_mfma_f32_16x16x32_bf16 v[52:55], a[48:51], v[124:127], v[52:55]
    ds_read_b64_tr_b16 v[100:101], v27 offset:20480
    v_mfma_f32_16x16x32_bf16 v[52:55], a[52:55], v[80:83], v[52:55]
    ds_read_b64_tr_b16 v[102:103], v27 offset:20992
    v_mfma_f32_16x16x32_bf16 v[56:59], a[48:51], v[80:83], v[56:59]
    ds_read_b128 v[76:79], v17 offset:36864
    v_mfma_f32_16x16x32_bf16 v[56:59], a[52:55], v[112:115], v[56:59]
    ds_read_b64_tr_b16 v[88:89], v27 offset:24576
    v_mfma_f32_16x16x32_bf16 v[44:47], a[56:59], v[124:127], v[44:47]
    ds_read_b64_tr_b16 v[90:91], v27 offset:25088
    v_mfma_f32_16x16x32_bf16 v[44:47], a[60:63], v[80:83], v[44:47]
    ds_read_b128 v[120:123], v17 offset:40960
    v_mfma_f32_16x16x32_bf16 v[48:51], a[56:59], v[80:83], v[48:51]
    ds_read_b128 v[92:95], v17 offset:46080
    v_mfma_f32_16x16x32_bf16 v[48:51], a[60:63], v[112:115], v[48:51]
    s_waitcnt lgkmcnt(7)
    v_mfma_f32_16x16x32_bf16 v[52:55], a[56:59], v[112:115], v[52:55]
    v_mfma_f32_16x16x32_bf16 v[52:55], a[60:63], v[108:111], v[52:55]
    ds_read_b128 v[84:87], v17 offset:50176
    v_mfma_f32_16x16x32_bf16 v[56:59], a[56:59], v[108:111], v[56:59]
    ds_read_b128 v[104:107], v19 offset:36864
    v_mfma_f32_16x16x32_bf16 v[56:59], a[60:63], v[96:99], v[56:59]
    ds_read_b64_tr_b16 v[116:117], v27 offset:28672
    s_waitcnt lgkmcnt(3)
    v_mfma_f32_16x16x32_bf16 v[44:47], v[100:103], v[76:79], v[44:47]
    ds_read_b64_tr_b16 v[118:119], v27 offset:29184
    v_mfma_f32_16x16x32_bf16 v[44:47], v[88:91], v[120:123], v[44:47]
    ds_read_b64_tr_b16 v[124:125], v27 offset:32768
    v_mfma_f32_16x16x32_bf16 v[48:51], v[100:103], v[120:123], v[48:51]
    ds_read_b64_tr_b16 v[126:127], v27 offset:33280
    v_mfma_f32_16x16x32_bf16 v[48:51], v[88:91], v[92:95], v[48:51]
    s_waitcnt lgkmcnt(4)
    v_mfma_f32_16x16x32_bf16 v[52:55], v[100:103], v[92:95], v[52:55]
    v_mfma_f32_16x16x32_bf16 v[52:55], v[88:91], v[84:87], v[52:55]
    ds_read_b128 v[80:83], v21 offset:36864
    v_mfma_f32_16x16x32_bf16 v[56:59], v[100:103], v[84:87], v[56:59]
    ds_read_b128 v[112:115], v19 offset:46080
    v_mfma_f32_16x16x32_bf16 v[56:59], v[88:91], v[104:107], v[56:59]
    ds_read_b64_tr_b16 v[108:109], v27 offset:36864
    s_waitcnt lgkmcnt(3)
    v_mfma_f32_16x16x32_bf16 v[44:47], v[116:119], v[92:95], v[44:47]
    ds_read_b64_tr_b16 v[110:111], v27 offset:37376
    v_mfma_f32_16x16x32_bf16 v[44:47], v[124:127], v[84:87], v[44:47]
    ds_read_b64_tr_b16 v[96:97], v27 offset:40960
    v_mfma_f32_16x16x32_bf16 v[48:51], v[116:119], v[84:87], v[48:51]
    ds_read_b64_tr_b16 v[98:99], v27 offset:41472
    v_mfma_f32_16x16x32_bf16 v[48:51], v[124:127], v[104:107], v[48:51]
    s_waitcnt lgkmcnt(4)
    v_mfma_f32_16x16x32_bf16 v[52:55], v[116:119], v[104:107], v[52:55]
    ds_read_b128 v[76:79], v21 offset:46080
    v_mfma_f32_16x16x32_bf16 v[52:55], v[124:127], v[80:83], v[52:55]
    ds_read_b128 v[120:123], v23 offset:36864
    v_mfma_f32_16x16x32_bf16 v[56:59], v[116:119], v[80:83], v[56:59]
    ds_read_b64_tr_b16 v[100:101], v26 offset:0
    v_mfma_f32_16x16x32_bf16 v[56:59], v[124:127], v[112:115], v[56:59]
    ds_read_b64_tr_b16 v[102:103], v26 offset:512
    s_waitcnt lgkmcnt(4)
    v_mfma_f32_16x16x32_bf16 v[44:47], v[108:111], v[104:107], v[44:47]
    ds_read_b64_tr_b16 v[88:89], v26 offset:4096
    v_mfma_f32_16x16x32_bf16 v[44:47], v[96:99], v[80:83], v[44:47]
    ds_read_b64_tr_b16 v[90:91], v26 offset:4608
    v_mfma_f32_16x16x32_bf16 v[48:51], v[108:111], v[80:83], v[48:51]
    ds_read_b128 v[92:95], v25 offset:36864
    v_mfma_f32_16x16x32_bf16 v[48:51], v[96:99], v[112:115], v[48:51]
    ds_read_b128 v[84:87], v23 offset:46080
    s_waitcnt lgkmcnt(6)
    v_mfma_f32_16x16x32_bf16 v[52:55], v[108:111], v[112:115], v[52:55]
    ds_read_b64_tr_b16 v[116:117], v26 offset:8192
    v_mfma_f32_16x16x32_bf16 v[52:55], v[96:99], v[76:79], v[52:55]
    ds_read_b64_tr_b16 v[118:119], v26 offset:8704
    v_mfma_f32_16x16x32_bf16 v[56:59], v[108:111], v[76:79], v[56:59]
    ds_read_b128 v[124:127], v16 offset:55296
    v_mfma_f32_16x16x32_bf16 v[56:59], v[96:99], v[120:123], v[56:59]
    ds_read_b64_tr_b16 v[104:105], v26 offset:12288
    s_waitcnt lgkmcnt(6)
    v_mfma_f32_16x16x32_bf16 v[44:47], v[100:103], v[112:115], v[44:47]
    ds_read_b64_tr_b16 v[106:107], v26 offset:12800
    v_mfma_f32_16x16x32_bf16 v[44:47], v[88:91], v[76:79], v[44:47]
    ds_read_b128 v[80:83], v16 offset:59392
    v_mfma_f32_16x16x32_bf16 v[48:51], v[100:103], v[76:79], v[48:51]
    ds_read_b128 v[108:111], v16 offset:64512
    v_mfma_f32_16x16x32_bf16 v[48:51], v[88:91], v[120:123], v[48:51]
    s_waitcnt lgkmcnt(7)
    v_mfma_f32_16x16x32_bf16 v[52:55], v[100:103], v[120:123], v[52:55]
    v_mfma_f32_16x16x32_bf16 v[52:55], v[88:91], v[92:95], v[52:55]
    v_add_u32 v31, 36864, v16
    ds_read_b128 v[96:99], v31 offset:31744
    v_mfma_f32_16x16x32_bf16 v[56:59], v[100:103], v[92:95], v[56:59]
    ds_read_b128 v[112:115], v18 offset:55296
    v_mfma_f32_16x16x32_bf16 v[56:59], v[88:91], v[84:87], v[56:59]
    ds_read_b64_tr_b16 v[76:77], v26 offset:16384
    s_waitcnt lgkmcnt(3)
    v_mfma_f32_16x16x32_bf16 v[44:47], v[116:119], v[124:127], v[44:47]
    ds_read_b64_tr_b16 v[78:79], v26 offset:16896
    v_mfma_f32_16x16x32_bf16 v[44:47], v[104:107], v[80:83], v[44:47]
    ds_read_b64_tr_b16 v[120:121], v26 offset:20480
    v_mfma_f32_16x16x32_bf16 v[48:51], v[116:119], v[80:83], v[48:51]
    ds_read_b64_tr_b16 v[122:123], v26 offset:20992
    v_mfma_f32_16x16x32_bf16 v[48:51], v[104:107], v[108:111], v[48:51]
    s_waitcnt lgkmcnt(4)
    v_mfma_f32_16x16x32_bf16 v[52:55], v[116:119], v[108:111], v[52:55]
    v_mfma_f32_16x16x32_bf16 v[52:55], v[104:107], v[96:99], v[52:55]
    ds_read_b128 v[92:95], v20 offset:55296
    s_waitcnt vmcnt(0)
    buffer_load_dwordx4 v[60:63], v15, s[32:35], s45 offen offset:0 sc1
    buffer_load_dwordx4 v[64:67], v15, s[32:35], s45 offen offset:1024 sc1
    buffer_load_dwordx4 v[68:71], v15, s[32:35], s45 offen offset:2048 sc1
    buffer_load_dwordx4 v[72:75], v15, s[32:35], s45 offen offset:3072 sc1
    v_mfma_f32_16x16x32_bf16 v[56:59], v[116:119], v[96:99], v[56:59]
    ds_read_b128 v[100:103], v18 offset:64512
    v_mfma_f32_16x16x32_bf16 v[56:59], v[104:107], v[112:115], v[56:59]
    ds_read_b64_tr_b16 v[84:85], v26 offset:24576
    s_waitcnt lgkmcnt(3)
    v_mfma_f32_16x16x32_bf16 v[44:47], v[76:79], v[108:111], v[44:47]
    ds_read_b64_tr_b16 v[86:87], v26 offset:25088
    v_mfma_f32_16x16x32_bf16 v[44:47], v[120:123], v[96:99], v[44:47]
    ds_read_b64_tr_b16 v[88:89], v26 offset:28672
    v_mfma_f32_16x16x32_bf16 v[48:51], v[76:79], v[96:99], v[48:51]
    ds_read_b64_tr_b16 v[90:91], v26 offset:29184
    v_mfma_f32_16x16x32_bf16 v[48:51], v[120:123], v[112:115], v[48:51]
    ds_read_b128 v[124:127], v20 offset:64512
    s_waitcnt lgkmcnt(5)
    v_mfma_f32_16x16x32_bf16 v[52:55], v[76:79], v[112:115], v[52:55]
    ds_read_b128 v[80:83], v22 offset:55296
    v_mfma_f32_16x16x32_bf16 v[52:55], v[120:123], v[92:95], v[52:55]
    ds_read_b64_tr_b16 v[116:117], v26 offset:32768
    v_mfma_f32_16x16x32_bf16 v[56:59], v[76:79], v[92:95], v[56:59]
    ds_read_b64_tr_b16 v[118:119], v26 offset:33280
    v_mfma_f32_16x16x32_bf16 v[56:59], v[120:123], v[100:103], v[56:59]
    ds_read_b128 v[104:107], v24 offset:55296
    s_waitcnt lgkmcnt(5)
    v_mfma_f32_16x16x32_bf16 v[44:47], v[84:87], v[112:115], v[44:47]
    ds_read_b64_tr_b16 v[108:109], v26 offset:36864
    v_mfma_f32_16x16x32_bf16 v[44:47], v[88:91], v[92:95], v[44:47]
    ds_read_b64_tr_b16 v[110:111], v26 offset:37376
    v_mfma_f32_16x16x32_bf16 v[48:51], v[84:87], v[92:95], v[48:51]
    ds_read_b128 v[96:99], v17 offset:55296
    v_mfma_f32_16x16x32_bf16 v[48:51], v[88:91], v[100:103], v[48:51]
    ds_read_b64_tr_b16 v[76:77], v26 offset:40960
    s_waitcnt lgkmcnt(7)
    v_mfma_f32_16x16x32_bf16 v[52:55], v[84:87], v[100:103], v[52:55]
    ds_read_b64_tr_b16 v[78:79], v26 offset:41472
    v_mfma_f32_16x16x32_bf16 v[52:55], v[88:91], v[124:127], v[52:55]
    ds_read_b128 v[120:123], v17 offset:59392
    v_mfma_f32_16x16x32_bf16 v[56:59], v[84:87], v[124:127], v[56:59]
    ds_read_b128 v[112:115], v17 offset:64512
    v_mfma_f32_16x16x32_bf16 v[56:59], v[88:91], v[80:83], v[56:59]
    s_waitcnt lgkmcnt(7)
    v_mfma_f32_16x16x32_bf16 v[44:47], v[116:119], v[100:103], v[44:47]
    v_mfma_f32_16x16x32_bf16 v[48:51], v[116:119], v[124:127], v[48:51]
    v_add_u32 v31, 36864, v17
    ds_read_b128 v[92:95], v31 offset:31744
    v_mfma_f32_16x16x32_bf16 v[52:55], v[116:119], v[80:83], v[52:55]
    ds_read_b128 v[84:87], v19 offset:55296
    v_mfma_f32_16x16x32_bf16 v[56:59], v[116:119], v[104:107], v[56:59]
    ds_read_b64_tr_b16 v[88:89], v27 offset:0
    s_waitcnt lgkmcnt(3)
    v_mfma_f32_16x16x32_bf16 v[44:47], v[108:111], v[96:99], v[44:47]
    ds_read_b64_tr_b16 v[90:91], v27 offset:512
    v_mfma_f32_16x16x32_bf16 v[44:47], v[76:79], v[120:123], v[44:47]
    ds_read_b64_tr_b16 v[100:101], v27 offset:4096
    v_mfma_f32_16x16x32_bf16 v[48:51], v[108:111], v[120:123], v[48:51]
    ds_read_b64_tr_b16 v[102:103], v27 offset:4608
    v_mfma_f32_16x16x32_bf16 v[48:51], v[76:79], v[112:115], v[48:51]
    s_waitcnt lgkmcnt(4)
    v_mfma_f32_16x16x32_bf16 v[52:55], v[108:111], v[112:115], v[52:55]
    v_mfma_f32_16x16x32_bf16 v[52:55], v[76:79], v[92:95], v[52:55]
    ds_read_b128 v[124:127], v21 offset:55296
    v_mfma_f32_16x16x32_bf16 v[56:59], v[108:111], v[92:95], v[56:59]
    ds_read_b128 v[80:83], v19 offset:64512
    v_mfma_f32_16x16x32_bf16 v[56:59], v[76:79], v[84:87], v[56:59]
    ds_read_b64_tr_b16 v[104:105], v27 offset:8192
    s_waitcnt lgkmcnt(3)
    v_mfma_f32_16x16x32_bf16 v[44:47], v[88:91], v[112:115], v[44:47]
    ds_read_b64_tr_b16 v[106:107], v27 offset:8704
    v_mfma_f32_16x16x32_bf16 v[44:47], v[100:103], v[92:95], v[44:47]
    ds_read_b64_tr_b16 v[116:117], v27 offset:12288
    v_mfma_f32_16x16x32_bf16 v[48:51], v[88:91], v[92:95], v[48:51]
    ds_read_b64_tr_b16 v[118:119], v27 offset:12800
    v_mfma_f32_16x16x32_bf16 v[48:51], v[100:103], v[84:87], v[48:51]
    s_waitcnt lgkmcnt(4)
    v_mfma_f32_16x16x32_bf16 v[52:55], v[88:91], v[84:87], v[52:55]
    v_mfma_f32_16x16x32_bf16 v[52:55], v[100:103], v[124:127], v[52:55]
    ds_read_b128 v[96:99], v21 offset:64512
    v_mfma_f32_16x16x32_bf16 v[56:59], v[88:91], v[124:127], v[56:59]
    ds_read_b128 v[120:123], v23 offset:55296
    v_mfma_f32_16x16x32_bf16 v[56:59], v[100:103], v[80:83], v[56:59]
    s_waitcnt lgkmcnt(2)
    v_mfma_f32_16x16x32_bf16 v[44:47], v[104:107], v[84:87], v[44:47]
    ds_read_b64_tr_b16 v[108:109], v27 offset:16384
    v_mfma_f32_16x16x32_bf16 v[44:47], v[116:119], v[124:127], v[44:47]
    ds_read_b64_tr_b16 v[110:111], v27 offset:16896
    v_mfma_f32_16x16x32_bf16 v[48:51], v[104:107], v[124:127], v[48:51]
    ds_read_b128 v[76:79], v25 offset:55296
    v_mfma_f32_16x16x32_bf16 v[48:51], v[116:119], v[80:83], v[48:51]
    s_waitcnt lgkmcnt(3)
    v_mfma_f32_16x16x32_bf16 v[52:55], v[104:107], v[80:83], v[52:55]
    v_mfma_f32_16x16x32_bf16 v[52:55], v[116:119], v[96:99], v[52:55]
    v_mfma_f32_16x16x32_bf16 v[56:59], v[104:107], v[96:99], v[56:59]
    v_mfma_f32_16x16x32_bf16 v[56:59], v[116:119], v[120:123], v[56:59]
    s_waitcnt lgkmcnt(0)
    v_mfma_f32_16x16x32_bf16 v[44:47], v[108:111], v[80:83], v[44:47]
    v_mfma_f32_16x16x32_bf16 v[48:51], v[108:111], v[96:99], v[48:51]
    v_mfma_f32_16x16x32_bf16 v[52:55], v[108:111], v[120:123], v[52:55]
    v_mfma_f32_16x16x32_bf16 v[56:59], v[108:111], v[76:79], v[56:59]
    s_mov_b32 s57, 0
L_recv:
    s_waitcnt vmcnt(0)
    v_min3_u32 v32, v61, v63, v65
    v_max3_u32 v33, v61, v63, v65
    v_min3_u32 v32, v32, v67, v69
    v_max3_u32 v33, v33, v67, v69
    v_min3_u32 v32, v32, v71, v73
    v_max3_u32 v33, v33, v71, v73
    v_min_u32 v32, v32, v75
    v_max_u32 v33, v33, v75
    v_cmp_eq_u32 vcc, v32, v2
    v_cmp_eq_u32 s[58:59], v33, v2
    s_and_b64 s[58:59], s[58:59], vcc
    s_cmp_eq_u64 s[58:59], -1
    s_cbranch_scc1 L_recv_ok
    s_add_u32 s57, s57, 1
    s_cmp_ge_u32 s57, 0x40000
    s_cbranch_scc1 L_recv_ok
    s_sleep 2
    buffer_load_dwordx4 v[60:63], v15, s[32:35], s45 offen offset:0 sc1
    buffer_load_dwordx4 v[64:67], v15, s[32:35], s45 offen offset:1024 sc1
    buffer_load_dwordx4 v[68:71], v15, s[32:35], s45 offen offset:2048 sc1
    buffer_load_dwordx4 v[72:75], v15, s[32:35], s45 offen offset:3072 sc1
    s_branch L_recv
L_recv_ok:
    v_and_b32 v61, 0xffff0000, v60
    v_lshlrev_b32 v60, 16, v60
    v_and_b32 v63, 0xffff0000, v62
    v_lshlrev_b32 v62, 16, v62
    v_and_b32 v65, 0xffff0000, v64
    v_lshlrev_b32 v64, 16, v64
    v_and_b32 v67, 0xffff0000, v66
    v_lshlrev_b32 v66, 16, v66
    v_and_b32 v69, 0xffff0000, v68
    v_lshlrev_b32 v68, 16, v68
    v_and_b32 v71, 0xffff0000, v70
    v_lshlrev_b32 v70, 16, v70
    v_and_b32 v73, 0xffff0000, v72
    v_lshlrev_b32 v72, 16, v72
    v_and_b32 v75, 0xffff0000, v74
    v_lshlrev_b32 v74, 16, v74
L_add:
    s_nop 4
    s_cmp_lg_u32 s40, 15
    v_pk_add_f32 v[44:45], v[44:45], v[60:61]
    v_pk_add_f32 v[46:47], v[46:47], v[62:63]
    v_pk_add_f32 v[48:49], v[48:49], v[64:65]
    v_pk_add_f32 v[50:51], v[50:51], v[66:67]
    v_pk_add_f32 v[52:53], v[52:53], v[68:69]
    v_pk_add_f32 v[54:55], v[54:55], v[70:71]
    v_pk_add_f32 v[56:57], v[56:57], v[72:73]
    v_pk_add_f32 v[58:59], v[58:59], v[74:75]
    s_cbranch_scc1 L_nomask
    v_cmp_lt_i32 vcc, 0, v7
    s_nop 1
    v_cndmask_b32 v44, 0, v44, vcc
    v_cndmask_b32 v45, 0, v45, vcc
    v_cndmask_b32 v46, 0, v46, vcc
    v_cndmask_b32 v47, 0, v47, vcc
    v_cmp_lt_i32 vcc, 1, v7
    s_nop 1
    v_cndmask_b32 v48, 0, v48, vcc
    v_cndmask_b32 v49, 0, v49, vcc
    v_cndmask_b32 v50, 0, v50, vcc
    v_cndmask_b32 v51, 0, v51, vcc
    v_cmp_lt_i32 vcc, 2, v7
    s_nop 1
    v_cndmask_b32 v52, 0, v52, vcc
    v_cndmask_b32 v53, 0, v53, vcc
    v_cndmask_b32 v54, 0, v54, vcc
    v_cndmask_b32 v55, 0, v55, vcc
    v_cmp_lt_i32 vcc, 3, v7
    s_nop 1
    v_cndmask_b32 v56, 0, v56, vcc
    v_cndmask_b32 v57, 0, v57, vcc
    v_cndmask_b32 v58, 0, v58, vcc
    v_cndmask_b32 v59, 0, v59, vcc
L_nomask:
    v_pk_add_f32 v[60:61], v[44:45], v[48:49]
    v_pk_add_f32 v[62:63], v[46:47], v[50:51]
    v_pk_mul_f32 v[64:65], v[44:45], v[44:45]
    v_pk_mul_f32 v[66:67], v[46:47], v[46:47]
    v_pk_add_f32 v[68:69], v[52:53], v[56:57]
    v_pk_add_f32 v[70:71], v[54:55], v[58:59]
    v_pk_fma_f32 v[64:65], v[48:49], v[48:49], v[64:65]
    v_pk_fma_f32 v[66:67], v[50:51], v[50:51], v[66:67]
    v_pk_add_f32 v[60:61], v[60:61], v[68:69]
    v_pk_add_f32 v[62:63], v[62:63], v[70:71]
    v_pk_fma_f32 v[64:65], v[52:53], v[52:53], v[64:65]
    v_pk_fma_f32 v[66:67], v[54:55], v[54:55], v[66:67]
    v_pk_fma_f32 v[64:65], v[56:57], v[56:57], v[64:65]
    v_pk_fma_f32 v[66:67], v[58:59], v[58:59], v[66:67]
    v_and_b32 v32, 1, v1
    v_cmp_ne_u32 vcc, 0, v32
    v_add_f32_dpp v68, v60, v60 row_ror:8 row_mask:0xf bank_mask:0x3
    v_add_f32_dpp v69, v61, v61 row_ror:8 row_mask:0xf bank_mask:0x3
    v_add_f32_dpp v70, v62, v62 row_ror:8 row_mask:0xf bank_mask:0x3
    v_add_f32_dpp v71, v63, v63 row_ror:8 row_mask:0xf bank_mask:0x3
    v_add_f32_dpp v68, v64, v64 row_ror:8 row_mask:0xf bank_mask:0xc
    v_add_f32_dpp v69, v65, v65 row_ror:8 row_mask:0xf bank_mask:0xc
    v_add_f32_dpp v70, v66, v66 row_ror:8 row_mask:0xf bank_mask:0xc
    v_add_f32_dpp v71, v67, v67 row_ror:8 row_mask:0xf bank_mask:0xc
    v_add_f32_dpp v60, v68, v68 row_shl:4 row_mask:0xf bank_mask:0x5
    v_add_f32_dpp v61, v69, v69 row_shl:4 row_mask:0xf bank_mask:0x5
    v_add_f32_dpp v60, v70, v70 row_shr:4 row_mask:0xf bank_mask:0xa
    v_add_f32_dpp v61, v71, v71 row_shr:4 row_mask:0xf bank_mask:0xa
    s_nop 0
    v_add_f32_dpp v62, v60, v60 quad_perm:[2,3,0,1] row_mask:0xf bank_mask:0xf
    v_add_f32_dpp v63, v61, v61 quad_perm:[2,3,0,1] row_mask:0xf bank_mask:0xf
    s_nop 0
    v_add_f32_dpp v60, v62, v62 quad_perm:[1,0,3,2] row_mask:0xf bank_mask:0xf
    v_add_f32_dpp v61, v63, v63 quad_perm:[1,0,3,2] row_mask:0xf bank_mask:0xf
    v_mov_b32 v33, v2
    v_cndmask_b32 v32, v60, v61, vcc
    buffer_store_dwordx2 v[32:33], v8, s[32:35], s55 offen sc1
    ds_write_b128 v12, v[44:47] offset:0
    ds_write_b128 v12, v[48:51] offset:128
    ds_write_b128 v12, v[52:55] offset:256
    ds_write_b128 v12, v[56:59] offset:384
    s_setprio 0
    s_branch L_join2
L_ld2:
    s_add_u32 m0, s47, 18432
    s_add_u32 s56, s92, 512
    s_waitcnt vmcnt(11)
    buffer_load_dwordx4 v17, s[20:23], s56 offen offset:0  lds
    s_waitcnt vmcnt(11)
    s_barrier
    buffer_load_dwordx4 v18, s[20:23], s56 offen offset:1024  lds
    s_waitcnt vmcnt(11)
    buffer_load_dwordx4 v19, s[20:23], s56 offen offset:2048  lds
    s_waitcnt vmcnt(11)
    s_barrier
    buffer_load_dwordx4 v22, s[20:23], s56 offen offset:3072  lds
    s_add_u32 m0, s48, 18432
    s_add_u32 s56, s92, 512
    s_mov_b32 exec_hi, 0
    s_waitcnt vmcnt(11)
    buffer_load_dwordx4 v23, s[20:23], s56 offen  lds
    s_mov_b32 exec_hi, -1
    s_add_u32 s58, s46, 49152
    s_add_u32 s59, s88, 1048576
    s_add_u32 m0, s58, s76
    s_add_u32 s56, s59, s80
    s_waitcnt vmcnt(11)
    buffer_load_dwordx4 v21, s[24:27], s56 offen  lds
    s_add_u32 m0, s58, s77
    s_add_u32 s56, s59, s81
    s_waitcnt vmcnt(11)
    buffer_load_dwordx4 v21, s[24:27], s56 offen  lds
    s_add_u32 m0, s58, s78
    s_add_u32 s56, s59, s82
    s_waitcnt vmcnt(11)
    s_barrier
    buffer_load_dwordx4 v21, s[24:27], s56 offen  lds
    s_add_u32 m0, s58, s79
    s_add_u32 s56, s59, s83
    s_waitcnt vmcnt(11)
    buffer_load_dwordx4 v21, s[24:27], s56 offen  lds
    s_add_u32 s58, s46, 65536
    s_add_u32 s59, s88, 131072
    s_add_u32 m0, s58, s76
    s_add_u32 s56, s59, s80
    s_waitcnt vmcnt(11)
    buffer_load_dwordx4 v20, s[24:27], s56 offen  lds
    s_add_u32 m0, s58, s77
    s_add_u32 s56, s59, s81
    s_waitcnt vmcnt(11)
    buffer_load_dwordx4 v20, s[24:27], s56 offen  lds
    s_add_u32 m0, s58, s78
    s_add_u32 s56, s59, s82
    s_waitcnt vmcnt(11)
    s_barrier
    s_mov_b32 s32, s18
    s_and_b32 s33, s19, 0xffff
    s_mov_b32 s34, 16777216
    s_mov_b32 s35, 0x20000
    s_lshl_b32 s50, s39, 2
    s_add_u32 s50, s50, s38
    s_lshl_b32 s51, s50, 8
    buffer_load_dword v2, off, s[32:35], s51 sc1
    s_lshl_b32 s52, s38, 7
    s_lshl_b32 s53, s36, 6
    s_add_u32 s52, s52, s53
    s_lshl_b32 s53, s3, 3
    s_add_u32 s53, s52, s53
    v_and_b32 v32, 3, v1
    v_lshl_add_u32 v33, v32, 1, s53
    global_load_ushort v3, v33, s[8:9]
    global_load_ushort v4, v33, s[10:11]
    global_load_ushort v5, v33, s[12:13]
    s_mul_i32 s53, s39, 1993*512
    s_add_u32 s28, s14, s53
    s_addc_u32 s29, s15, 0
    s_and_b32 s29, s29, 0xffff
    s_mov_b32 s30, 1993*512
    s_mov_b32 s31, 0x20000
    s_lshl_b32 s54, s50, 1
    s_add_u32 s54, s54, s36
    s_lshl_b32 s54, s54, 14
    s_add_u32 s54, s54, 65536
    s_lshl_b32 s55, s40, 10
    s_add_u32 s55, s55, s54
    v_lshrrev_b32 v33, 2, v1
    v_lshlrev_b32 v34, 9, v33
    v_lshl_add_u32 v34, v32, 4, v34
    s_lshl_b32 s53, s3, 6
    v_add_u32 v9, s53, v34
    s_lshl_b32 s53, s3, 4
    s_add_u32 s53, s53, 16384
    v_lshl_add_u32 v10, v32, 2, s53
    v_lshlrev_b32 v34, 5, v32
    v_add_u32 v11, 16384, v34
    s_lshl_b32 s53, s3, 4
    v_add_u32 v33, s53, v33
    s_lshl_b32 s53, s40, 7
    v_add_u32 v34, s53, v33
    v_lshlrev_b32 v34, 9, v34
    v_lshl_add_u32 v34, v32, 4, v34
    v_add_u32 v6, s52, v34
    v_bfe_u32 v34, v33, 2, 3
    v_lshlrev_b32 v35, 1, v32
    v_xor_b32 v34, v34, v35
    v_lshlrev_b32 v35, 7, v33
    v_lshl_add_u32 v34, v34, 4, v35
    v_add_u32 v13, 0, v34
    v_xor_b32 v14, 16, v13
    buffer_load_dwordx4 v20, s[24:27], s56 offen  lds
    s_add_u32 m0, s58, s79
    s_add_u32 s56, s59, s83
    s_waitcnt vmcnt(11)
    buffer_load_dwordx4 v20, s[24:27], s56 offen  lds
    s_add_u32 m0, s46, 81920
    s_add_u32 s56, s88, 1179648
    s_waitcnt vmcnt(11)
    buffer_load_dwordx4 v20, s[24:27], s56 offen  lds
    s_add_u32 m0, s46, 86016
    s_add_u32 s56, s88, 1441792
    s_waitcnt vmcnt(11)
    buffer_load_dwordx4 v20, s[24:27], s56 offen  lds
    s_add_u32 m0, s46, 0
    s_add_u32 s56, s88, 1703936
    s_waitcnt vmcnt(11)
    buffer_load_dwordx4 v20, s[24:27], s56 offen  lds
    s_waitcnt vmcnt(11)
    s_barrier
    s_add_u32 s58, s46, 4096
    s_add_u32 s59, s88, 131072
    s_add_u32 m0, s58, s76
    s_add_u32 s56, s59, s80
    buffer_load_dwordx4 v21, s[24:27], s56 offen  lds
    s_add_u32 m0, s58, s77
    s_add_u32 s56, s59, s81
    s_waitcnt vmcnt(11)
    buffer_load_dwordx4 v21, s[24:27], s56 offen  lds
    s_add_u32 m0, s58, s78
    s_add_u32 s56, s59, s82
    s_waitcnt vmcnt(11)
    buffer_load_dwordx4 v21, s[24:27], s56 offen  lds
    s_add_u32 m0, s58, s79
    s_add_u32 s56, s59, s83
    s_waitcnt vmcnt(11)
    buffer_load_dwordx4 v21, s[24:27], s56 offen  lds
    s_add_u32 m0, s47, 36864
    s_add_u32 s56, s93, 0
    s_waitcnt vmcnt(11)
    buffer_load_dwordx4 v17, s[20:23], s56 offen offset:0  lds
    s_waitcnt vmcnt(11)
    buffer_load_dwordx4 v18, s[20:23], s56 offen offset:1024  lds
    s_waitcnt vmcnt(11)
    buffer_load_dwordx4 v19, s[20:23], s56 offen offset:2048  lds
    s_waitcnt vmcnt(11)
    buffer_load_dwordx4 v22, s[20:23], s56 offen offset:3072  lds
    s_add_u32 m0, s48, 36864
    s_add_u32 s56, s93, 0
    s_mov_b32 exec_hi, 0
    s_waitcnt vmcnt(11)
    buffer_load_dwordx4 v23, s[20:23], s56 offen  lds
    s_mov_b32 exec_hi, -1
    s_add_u32 m0, s46, 20480
    s_add_u32 s56, s88, 1179648
    s_waitcnt vmcnt(11)
    s_barrier
    buffer_load_dwordx4 v21, s[24:27], s56 offen  lds
    s_add_u32 m0, s46, 24576
    s_add_u32 s56, s88, 1441792
    s_waitcnt vmcnt(11)
    buffer_load_dwordx4 v21, s[24:27], s56 offen  lds
    s_add_u32 m0, s46, 28672
    s_add_u32 s56, s88, 1703936
    s_waitcnt vmcnt(11)
    s_barrier
    buffer_load_dwordx4 v21, s[24:27], s56 offen  lds
    s_add_u32 s58, s46, 32768
    s_add_u32 s59, s89, 0
    s_add_u32 m0, s58, s76
    s_add_u32 s56, s59, s80
    s_waitcnt vmcnt(11)
    buffer_load_dwordx4 v20, s[24:27], s56 offen  lds
    s_add_u32 m0, s58, s77
    s_add_u32 s56, s59, s81
    s_waitcnt vmcnt(11)
    buffer_load_dwordx4 v20, s[24:27], s56 offen  lds
    s_add_u32 m0, s58, s78
    s_add_u32 s56, s59, s82
    s_waitcnt vmcnt(11)
    buffer_load_dwordx4 v20, s[24:27], s56 offen  lds
    s_add_u32 m0, s58, s79
    s_add_u32 s56, s59, s83
    s_waitcnt vmcnt(11)
    s_barrier
    buffer_load_dwordx4 v20, s[24:27], s56 offen  lds
    s_add_u32 s58, s46, 49152
    s_add_u32 s59, s89, 1048576
    s_add_u32 m0, s58, s76
    s_add_u32 s56, s59, s80
    s_waitcnt vmcnt(11)
    buffer_load_dwordx4 v20, s[24:27], s56 offen  lds
    s_add_u32 m0, s58, s77
    s_add_u32 s56, s59, s81
    s_waitcnt vmcnt(11)
    buffer_load_dwordx4 v20, s[24:27], s56 offen  lds
    s_add_u32 m0, s58, s78
    s_add_u32 s56, s59, s82
    s_waitcnt vmcnt(11)
    buffer_load_dwordx4 v20, s[24:27], s56 offen  lds
    s_add_u32 m0, s58, s79
    s_add_u32 s56, s59, s83
    s_waitcnt vmcnt(11)
    buffer_load_dwordx4 v20, s[24:27], s56 offen  lds
    s_add_u32 s58, s46, 65536
    s_add_u32 s59, s89, 0
    s_add_u32 m0, s58, s76
    s_add_u32 s56, s59, s80
    s_waitcnt vmcnt(11)
    buffer_load_dwordx4 v21, s[24:27], s56 offen  lds
    s_add_u32 m0, s58, s77
    s_add_u32 s56, s59, s81
    s_waitcnt vmcnt(11)
    buffer_load_dwordx4 v21, s[24:27], s56 offen  lds
    s_add_u32 m0, s58, s78
    s_add_u32 s56, s59, s82
    s_waitcnt vmcnt(11)
    buffer_load_dwordx4 v21, s[24:27], s56 offen  lds
    s_add_u32 m0, s58, s79
    s_add_u32 s56, s59, s83
    s_waitcnt vmcnt(11)
    s_barrier
    buffer_load_dwordx4 v21, s[24:27], s56 offen  lds
    s_waitcnt vmcnt(8)
    s_barrier
    s_add_u32 m0, s47, 55296
    s_add_u32 s56, s93, 512
    buffer_load_dwordx4 v17, s[20:23], s56 offen offset:0  lds
    buffer_load_dwordx4 v18, s[20:23], s56 offen offset:1024  lds
    buffer_load_dwordx4 v19, s[20:23], s56 offen offset:2048  lds
    buffer_load_dwordx4 v22, s[20:23], s56 offen offset:3072  lds
    s_add_u32 m0, s48, 55296
    s_add_u32 s56, s93, 512
    s_mov_b32 exec_hi, 0
    s_waitcnt vmcnt(11)
    buffer_load_dwordx4 v23, s[20:23], s56 offen  lds
    s_mov_b32 exec_hi, -1
    s_add_u32 m0, s46, 81920
    s_add_u32 s56, s89, 1048576
    s_waitcnt vmcnt(11)
    buffer_load_dwordx4 v21, s[24:27], s56 offen  lds
    s_add_u32 m0, s46, 86016
    s_add_u32 s56, s89, 1310720
    s_waitcnt vmcnt(11)
    buffer_load_dwordx4 v21, s[24:27], s56 offen  lds
    s_add_u32 m0, s46, 0
    s_add_u32 s56, s89, 1572864
    s_waitcnt vmcnt(11)
    s_barrier
    buffer_load_dwordx4 v21, s[24:27], s56 offen  lds
    s_add_u32 m0, s46, 4096
    s_add_u32 s56, s89, 1835008
    s_waitcnt vmcnt(11)
    buffer_load_dwordx4 v21, s[24:27], s56 offen  lds
    s_add_u32 s58, s46, 8192
    s_add_u32 s59, s89, 131072
    s_add_u32 m0, s58, s76
    s_add_u32 s56, s59, s80
    s_waitcnt vmcnt(11)
    buffer_load_dwordx4 v20, s[24:27], s56 offen  lds
    s_add_u32 m0, s58, s77
    s_add_u32 s56, s59, s81
    s_waitcnt vmcnt(11)
    buffer_load_dwordx4 v20, s[24:27], s56 offen  lds
    s_add_u32 m0, s58, s78
    s_add_u32 s56, s59, s82
    s_waitcnt vmcnt(11)
    s_barrier
    buffer_load_dwordx4 v20, s[24:27], s56 offen  lds
    s_add_u32 m0, s58, s79
    s_add_u32 s56, s59, s83
    s_waitcnt vmcnt(11)
    buffer_load_dwordx4 v20, s[24:27], s56 offen  lds
    s_add_u32 m0, s46, 24576
    s_add_u32 s56, s89, 1179648
    s_waitcnt vmcnt(11)
    buffer_load_dwordx4 v20, s[24:27], s56 offen  lds
    s_add_u32 m0, s46, 28672
    s_add_u32 s56, s89, 1441792
    s_waitcnt vmcnt(11)
    buffer_load_dwordx4 v20, s[24:27], s56 offen  lds
    s_add_u32 m0, s46, 32768
    s_add_u32 s56, s89, 1703936
    s_waitcnt vmcnt(11)
    buffer_load_dwordx4 v20, s[24:27], s56 offen  lds
    s_waitcnt vmcnt(7)
    s_barrier
    s_add_u32 s58, s46, 36864
    s_add_u32 s59, s89, 131072
    s_add_u32 m0, s58, s76
    s_add_u32 s56, s59, s80
    buffer_load_dwordx4 v21, s[24:27], s56 offen  lds
    s_add_u32 m0, s58, s77
    s_add_u32 s56, s59, s81
    buffer_load_dwordx4 v21, s[24:27], s56 offen  lds
    s_add_u32 m0, s58, s78
    s_add_u32 s56, s59, s82
    buffer_load_dwordx4 v21, s[24:27], s56 offen  lds
    s_add_u32 m0, s58, s79
    s_add_u32 s56, s59, s83
    buffer_load_dwordx4 v21, s[24:27], s56 offen  lds
    s_add_u32 m0, s46, 53248
    s_add_u32 s56, s89, 1179648
    buffer_load_dwordx4 v21, s[24:27], s56 offen  lds
    s_add_u32 m0, s46, 57344
    s_add_u32 s56, s89, 1441792
    s_waitcnt vmcnt(11)
    buffer_load_dwordx4 v21, s[24:27], s56 offen  lds
    s_add_u32 m0, s46, 61440
    s_add_u32 s56, s89, 1703936
    s_waitcnt vmcnt(11)
    buffer_load_dwordx4 v21, s[24:27], s56 offen  lds
    s_waitcnt vmcnt(10)
    s_barrier
    s_waitcnt vmcnt(7)
    s_barrier
    s_waitcnt vmcnt(3)
    s_barrier
    s_waitcnt vmcnt(0)
    s_barrier
L_join:
    s_waitcnt vmcnt(0)
    v_add_u32 v2, 0x9e3779b8, v2
    v_or_b32 v2, 1, v2
    v_lshlrev_b32 v3, 16, v3
    v_lshlrev_b32 v4, 16, v4
    v_lshlrev_b32 v5, 16, v5
L_join2:
    s_waitcnt lgkmcnt(0)
    s_barrier
    ds_read_b128 v[72:75], v13
    ds_read_b128 v[76:79], v14
    s_sleep 12
L_nosleep:
    s_mov_b32 s56, 0x3
    s_mov_b32 s57, 0
L_gath:
    s_bitcmp0_b32 s56, 0
    s_cbranch_scc1 L_gi0
    s_add_u32 s49, s54, 0
    buffer_load_dwordx4 v[40:43], v9, s[32:35], s49 offen sc1
L_gi0:
    s_bitcmp0_b32 s56, 1
    s_cbranch_scc1 L_gi1
    s_add_u32 s49, s54, 8192
    buffer_load_dwordx4 v[44:47], v9, s[32:35], s49 offen sc1
L_gi1:
    s_waitcnt vmcnt(0)
    v_cmp_eq_u32 vcc, v41, v2
    v_cmp_eq_u32 s[58:59], v43, v2
    s_and_b64 s[58:59], s[58:59], vcc
    s_cmp_eq_u64 s[58:59], -1
    s_cselect_b32 s49, 1, 0
    s_andn2_b32 s56, s56, s49
    v_cmp_eq_u32 vcc, v45, v2
    v_cmp_eq_u32 s[58:59], v47, v2
    s_and_b64 s[58:59], s[58:59], vcc
    s_cmp_eq_u64 s[58:59], -1
    s_cselect_b32 s49, 2, 0
    s_andn2_b32 s56, s56, s49
    s_cbranch_scc0 L_gath_ok
    s_add_u32 s57, s57, 1
    s_cmp_lt_u32 s57, 0x40000
    s_cbranch_scc1 L_gath
L_gath_ok:
    v_add_f32 v32, v40, v44
    v_add_f32 v33, v42, v46
    s_nop 1
    v_permlane32_swap_b32 v32, v33
    v_add_f32 v32, v32, v33
    v_mov_b32 v33, v32
    s_nop 1
    v_permlane16_swap_b32 v32, v33
    v_add_f32 v32, v32, v33
    s_nop 1
    v_add_f32_dpp v33, v32, v32 row_ror:8 row_mask:0xf bank_mask:0xf
    s_nop 1
    v_add_f32_dpp v34, v33, v33 row_ror:4 row_mask:0xf bank_mask:0xf
    v_mul_f32 v32, 0x3a038849, v34
    v_mul_f32 v33, 0x3a038849, v34
    s_nop 1
    v_permlane32_swap_b32 v32, v33
    v_fma_f32 v33, -v32, v32, v33
    v_max_f32 v33, 0, v33
    v_add_f32 v33, 0x3727c5ac, v33
    v_rsq_f32 v33, v33
    v_add_f32 v32, v32, v3
    v_sub_f32 v32, v3, v32
    v_mul_f32 v34, v33, v4
    v_fma_f32 v35, v32, v34, v5
    ds_write2st64_b32 v10, v34, v35 offset0:0 offset1:1
    s_mov_b32 s58, 0xbdd2d3e8
    s_mov_b32 s59, s58
    v_mov_b32 v36, 0xc0135761
    v_mov_b32 v37, v36
    s_waitcnt lgkmcnt(0)
    s_barrier
    ds_read_b128 v[40:43], v11
    ds_read_b128 v[48:51], v11 offset:256
    ds_read_b128 v[44:47], v11 offset:16
    ds_read_b128 v[52:55], v11 offset:272
    s_or_b32 s49, s40, s3
    s_or_b32 s49, s49, s36
    s_cmp_lg_u32 s49, 0
    s_cbranch_scc1 L_noepoch
    s_mov_b64 exec, 1
    buffer_store_dword v2, off, s[32:35], s51 sc1
    s_mov_b64 exec, -1
L_noepoch:
    s_waitcnt lgkmcnt(2)
    v_pk_fma_f32 v[56:57], v[72:73], v[40:41], v[48:49]
    v_pk_fma_f32 v[58:59], v[74:75], v[42:43], v[50:51]
    s_waitcnt lgkmcnt(0)
    v_pk_fma_f32 v[60:61], v[76:77], v[44:45], v[52:53]
    v_pk_fma_f32 v[62:63], v[78:79], v[46:47], v[54:55]
    v_pk_mul_f32 v[64:65], v[56:57], v[56:57]
    v_pk_mul_f32 v[66:67], v[58:59], v[58:59]
    v_pk_mul_f32 v[68:69], v[60:61], v[60:61]
    v_pk_mul_f32 v[70:71], v[62:63], v[62:63]
    v_pk_fma_f32 v[64:65], v[64:65], s[58:59], v[36:37]
    v_pk_fma_f32 v[66:67], v[66:67], s[58:59], v[36:37]
    v_pk_fma_f32 v[68:69], v[68:69], s[58:59], v[36:37]
    v_pk_fma_f32 v[70:71], v[70:71], s[58:59], v[36:37]
    v_pk_mul_f32 v[64:65], v[64:65], v[56:57]
    v_pk_mul_f32 v[66:67], v[66:67], v[58:59]
    v_pk_mul_f32 v[68:69], v[68:69], v[60:61]
    v_pk_mul_f32 v[70:71], v[70:71], v[62:63]
    v_exp_f32 v64, v64
    v_exp_f32 v65, v65
    v_exp_f32 v66, v66
    v_exp_f32 v67, v67
    v_exp_f32 v68, v68
    v_exp_f32 v69, v69
    v_exp_f32 v70, v70
    v_exp_f32 v71, v71
    v_pk_add_f32 v[64:65], v[64:65], 1.0 op_sel_hi:[1,0]
    v_pk_add_f32 v[66:67], v[66:67], 1.0 op_sel_hi:[1,0]
    v_pk_add_f32 v[68:69], v[68:69], 1.0 op_sel_hi:[1,0]
    v_pk_add_f32 v[70:71], v[70:71], 1.0 op_sel_hi:[1,0]
    v_rcp_f32 v64, v64
    v_rcp_f32 v65, v65
    v_rcp_f32 v66, v66
    v_rcp_f32 v67, v67
    v_rcp_f32 v68, v68
    v_rcp_f32 v69, v69
    v_rcp_f32 v70, v70
    v_rcp_f32 v71, v71
    v_pk_mul_f32 v[56:57], v[56:57], v[64:65]
    v_pk_mul_f32 v[58:59], v[58:59], v[66:67]
    v_pk_mul_f32 v[60:61], v[60:61], v[68:69]
    v_pk_mul_f32 v[62:63], v[62:63], v[70:71]
    v_cvt_pk_bf16_f32 v40, v56, v57
    v_cvt_pk_bf16_f32 v41, v58, v59
    v_cvt_pk_bf16_f32 v42, v60, v61
    v_cvt_pk_bf16_f32 v43, v62, v63
    buffer_store_dwordx4 v[40:43], v6, s[28:31], 0 offen sc0 sc1
L_done:
    s_endpgm
.section .rodata,"a"
.p2align 6
.amdhsa_kernel standalone__self_sup_conv_stem_hubert__speech_kernel
  .amdhsa_next_free_vgpr 256
  .amdhsa_next_free_sgpr 100
  .amdhsa_accum_offset 128
  .amdhsa_group_segment_fixed_size 0
  .amdhsa_kernarg_size 64
  .amdhsa_user_sgpr_count 2
  .amdhsa_user_sgpr_kernarg_segment_ptr 1
  .amdhsa_system_sgpr_workgroup_id_x 1
  .amdhsa_float_denorm_mode_32 3
.end_amdhsa_kernel
```
